```python
import torch

def _softmax(x, axis=-1):
    return torch.softmax(x, dim=axis)
def _gelu(x):
    return torch.nn.functional.gelu(x, approximate="tanh")
def _silu(x):
    return torch.nn.functional.silu(x)
def _sigmoid(x):
    return torch.sigmoid(x)
def _layernorm(x, axis=-1, eps=1e-5):
    m = x.mean(dim=axis, keepdim=True)
    v = x.var(dim=axis, keepdim=True, unbiased=False)
    return (x - m) / torch.sqrt(v + eps)
def _scatter_add(tgt, idx, src, axis=0):
    return tgt.clone().index_add_(axis, idx, src)
def _segment_sum(src, seg, n):
    out = torch.zeros((n,) + src.shape[1:], dtype=src.dtype)
    return out.index_add_(0, seg, src)
def _pad(x, pw):
    flat = tuple(v for pair in reversed(pw) for v in pair)
    return torch.nn.functional.pad(x, flat)

kernel_name = 'sequential_preLN__gqa_block_cached__dense_activation_squared_relu__decode'

def setup_inputs():

    _w = (lambda a: (lambda t: t.to(torch.bfloat16) if t.is_floating_point() else t)(torch.as_tensor(a)))
    def _A_setup():
        B, Sq, D = 1, 1, 512
        Hq, Hkv, Sk, Dh = 32, 8, 65536, 128
        assert Hq % Hkv == 0, (Hq, Hkv)
        return {
            "x": _w((lambda *s: torch.randn(*s, dtype=torch.bfloat16) * 0.05)(B, Sq, D)),
            "k_cache": _w((lambda *s: torch.randn(*s, dtype=torch.bfloat16) * 3.2)(B, Hkv, Sk, Dh)),
            "v_cache": _w((lambda *s: torch.randn(*s, dtype=torch.bfloat16) * 0.4)(B, Hkv, Sk, Dh)),
            "wq": _w((lambda *s: torch.randn(*s, dtype=torch.bfloat16) * 3.2)(D, Hq * Dh) * (D ** -0.5)),
            "wo": _w((lambda *s: torch.randn(*s, dtype=torch.bfloat16) * 0.4)(Hq * Dh, D) * ((Hq * Dh) ** -0.5)),
        }
    _A_in = _A_setup()

    def _B_setup():
        B, S, D, F = 1, 1, 512, 1792
        return {
            "x": _w((lambda *s: torch.randn(*s, dtype=torch.bfloat16) * 0.05)(B, S, D)),
            "w1": _w((lambda *s: torch.randn(*s, dtype=torch.bfloat16) * 0.05)(D, F)),
            "b1": _w((lambda *s: torch.randn(*s, dtype=torch.bfloat16) * 0.8)(F)),
            "w2": _w((lambda *s: torch.randn(*s, dtype=torch.bfloat16) * 0.05)(F, D)),
            "b2": _w((lambda *s: torch.randn(*s, dtype=torch.bfloat16) * 3.2)(D)),
        }
    _B_in = _B_setup()

    return {
        "A_x": _A_in["x"],
        "A_k_cache": _A_in["k_cache"],
        "A_v_cache": _A_in["v_cache"],
        "A_wq": _A_in["wq"],
        "A_wo": _A_in["wo"],
        "B_x": _B_in["x"],
        "B_w1": _B_in["w1"],
        "B_b1": _B_in["b1"],
        "B_w2": _B_in["w2"],
        "B_b2": _B_in["b2"],
    }

def reference(A_x, A_k_cache, A_v_cache, A_wq, A_wo, B_x, B_w1, B_b1, B_w2, B_b2):
    def _A_ref(x, k_cache, v_cache, wq, wo):
        B, Sq, D = x.shape
        Hq, Dh = 32, 128
        Hkv = k_cache.shape[1]
        rep = Hq // Hkv
        q = (lambda x, *d: x.permute(*d))((x @ wq).reshape(B, Sq, Hq, Dh), 0, 2, 1, 3)
        k = (lambda x, n, axis: torch.repeat_interleave(x, n, dim=axis))(k_cache, rep, axis=1)
        v = (lambda x, n, axis: torch.repeat_interleave(x, n, dim=axis))(v_cache, rep, axis=1)
        scores = torch.einsum("bhqd,bhkd->bhqk", q, k) * (Dh ** -0.5)
        p = _softmax(scores, axis=-1)
        o = torch.einsum("bhqk,bhkd->bhqd", p, v)
        return (lambda x, *d: x.permute(*d))(o, 0, 2, 1, 3).reshape(B, Sq, Hq * Dh) @ wo

    def _B_ref(x, w1, b1, w2, b2):
        h = torch.einsum("bsd,df->bsf", x, w1) + b1
        zero = torch.zeros_like(h)
        r = torch.where(h > zero, h, zero)
        h = r * r
        out = torch.einsum("bsf,fd->bsd", h, w2) + b2
        return out

    x = A_x
    h = x + _A_ref(_layernorm(x, axis=-1), A_k_cache, A_v_cache, A_wq, A_wo)
    h2 = h + _B_ref(_layernorm(h, axis=-1), B_w1, B_b1, B_w2, B_b2)
    return h2
```

```asm
; @launch kernel=k2_attn_kernel grid=(256,1,1) block=(512,1,1) lds=19968
; @launch kernel=k3_tail_kernel grid=(128,1,1) block=(512,1,1) lds=24576
.amdgcn_target "amdgcn-amd-amdhsa--gfx950"
.text
.globl k2_attn_kernel
.p2align 8
.type k2_attn_kernel,@function
k2_attn_kernel:
    s_cmp_ge_u32 s2, 256
    s_cbranch_scc1 k2_end
    s_load_dwordx16 s[64:79], s[0:1], 0
    s_load_dwordx8 s[80:87], s[0:1], 64
    s_load_dwordx2 s[88:89], s[0:1], 96
    v_readfirstlane_b32 s3, v0
    s_nop 3
    s_lshr_b32 s3, s3, 6
    s_lshr_b32 s10, s2, 5
    s_and_b32 s11, s2, 31
    s_mov_b32 s28, 0x05040100
    s_mov_b32 s29, 0x07060302
    s_mov_b32 s30, 1035273459
    s_mov_b32 s31, 1069066811
    s_mov_b32 s33, 0x3b000000
    s_mov_b32 s40, 0
    s_mov_b32 s41, 65536
    s_mov_b32 s42, 131072
    s_mov_b32 s43, 196608
    s_mov_b32 s44, 262144
    s_mov_b32 s45, 327680
    s_mov_b32 s46, 393216
    s_mov_b32 s47, 458752
    v_and_b32 v1, 15, v0
    v_bfe_u32 v2, v0, 4, 2
    v_lshrrev_b32 v3, 6, v0
    v_lshrrev_b32 v4, 2, v1
    v_lshlrev_b32 v4, 11, v4
    v_and_b32 v5, 3, v1
    v_lshl_add_u32 v4, v5, 8, v4
    v_lshl_add_u32 v4, v2, 4, v4
    v_lshl_add_u32 v4, v3, 13, v4
    v_lshlrev_b32 v5, 11, v2
    v_lshl_add_u32 v5, v1, 4, v5
    v_lshl_add_u32 v5, v3, 13, v5
    s_lshl_b32 s12, s10, 24
    s_lshl_b32 s13, s11, 19
    s_add_u32 s12, s12, s13
    s_waitcnt lgkmcnt(0)
    s_add_u32 s4, s66, s12
    s_addc_u32 s5, s67, 0
    s_add_u32 s6, s68, s12
    s_addc_u32 s7, s69, 0
    s_mov_b32 s16, s4
    s_and_b32 s17, s5, 0xffff
    s_mov_b32 s18, 524288
    s_mov_b32 s19, 0x00020000
    s_mov_b32 s20, s6
    s_and_b32 s21, s7, 0xffff
    s_mov_b32 s22, 524288
    s_mov_b32 s23, 0x00020000
    s_mov_b32 s24, s88
    s_and_b32 s25, s89, 0xffff
    s_mov_b32 s26, 536870912
    s_mov_b32 s27, 0x00020000
    s_or_b32 s12, s2, s3
    s_cmp_lg_u32 s12, 0
    s_cbranch_scc1 tag_pub_done
    s_memrealtime s[54:55]
    s_waitcnt lgkmcnt(0)
    s_or_b32 s54, s54, 1
    v_mov_b32 v8, s54
    v_mov_b32 v9, 0
    s_mov_b64 s[52:53], exec
    s_mov_b64 exec, 1
    global_store_dword v9, v8, s[86:87] sc1
    s_mov_b64 exec, s[52:53]
tag_pub_done:
    s_cmp_ge_u32 s2, 128
    s_cbranch_scc1 pro_q
    v_mov_b32 v8, 0
    v_mov_b32 v9, 0
    v_lshlrev_b32 v6, 3, v0
    s_lshl_b32 s12, s2, 11
    s_add_u32 s12, s12, 598016
    v_cmp_gt_u32 vcc, 256, v0
    s_and_saveexec_b64 s[52:53], vcc
    buffer_store_dwordx2 v[8:9], v6, s[24:27], s12 offen
    s_mov_b64 exec, s[52:53]
    s_waitcnt vmcnt(0)
    s_branch pro_done
pro_q:
    s_sub_u32 s14, s2, 128
    s_mov_b32 s36, s70
    s_and_b32 s37, s71, 0xffff
    s_mov_b32 s38, 4194304
    s_mov_b32 s39, 0x00020000
    s_mov_b32 s92, s64
    s_and_b32 s93, s65, 0xffff
    s_mov_b32 s94, 1024
    s_mov_b32 s95, 0x00020000
    v_lshrrev_b32 v6, 2, v0
    v_and_b32 v7, 3, v0
    v_and_b32 v8, 63, v0
    v_lshlrev_b32 v8, 4, v8
    v_lshlrev_b32 v9, 3, v6
    buffer_load_dwordx4 v[8:11], v8, s[92:95], 0 offen
    buffer_load_dwordx2 v[12:13], v9, s[92:95], 0 offen
    v_lshlrev_b32 v6, 15, v6
    v_lshl_add_u32 v6, v7, 4, v6
    s_lshl_b32 s12, s14, 6
    s_add_u32 s13, s12, 0
    buffer_load_dwordx4 v[32:35], v6, s[36:39], s13 offen
    s_add_u32 s13, s12, 8192
    buffer_load_dwordx4 v[36:39], v6, s[36:39], s13 offen
    s_add_u32 s13, s12, 16384
    buffer_load_dwordx4 v[40:43], v6, s[36:39], s13 offen
    s_add_u32 s13, s12, 24576
    buffer_load_dwordx4 v[44:47], v6, s[36:39], s13 offen
    s_waitcnt vmcnt(5)
    v_lshlrev_b32 v16, 16, v8
    v_and_b32 v17, 0xffff0000, v8
    v_lshlrev_b32 v18, 16, v9
    v_and_b32 v19, 0xffff0000, v9
    v_lshlrev_b32 v20, 16, v10
    v_and_b32 v21, 0xffff0000, v10
    v_lshlrev_b32 v22, 16, v11
    v_and_b32 v23, 0xffff0000, v11
    v_add_f32 v24, v16, v17
    v_add_f32 v24, v24, v18
    v_add_f32 v24, v24, v19
    v_add_f32 v24, v24, v20
    v_add_f32 v24, v24, v21
    v_add_f32 v24, v24, v22
    v_add_f32 v24, v24, v23
    s_nop 1
    v_add_f32_dpp v24, v24, v24 quad_perm:[1,0,3,2] row_mask:0xf bank_mask:0xf
    s_nop 1
    v_add_f32_dpp v24, v24, v24 quad_perm:[2,3,0,1] row_mask:0xf bank_mask:0xf
    s_nop 1
    v_add_f32_dpp v24, v24, v24 row_half_mirror row_mask:0xf bank_mask:0xf
    s_nop 1
    v_add_f32_dpp v24, v24, v24 row_mirror row_mask:0xf bank_mask:0xf
    v_mov_b32 v25, v24
    s_nop 1
    v_permlane16_swap_b32 v24, v25
    s_nop 1
    v_add_f32 v24, v24, v25
    v_mov_b32 v25, v24
    s_nop 1
    v_permlane32_swap_b32 v24, v25
    s_nop 1
    v_add_f32 v24, v24, v25
    v_mul_f32 v24, s33, v24
    v_sub_f32 v25, v16, v24
    v_mul_f32 v27, v25, v25
    v_sub_f32 v25, v17, v24
    v_fmac_f32 v27, v25, v25
    v_sub_f32 v25, v18, v24
    v_fmac_f32 v27, v25, v25
    v_sub_f32 v25, v19, v24
    v_fmac_f32 v27, v25, v25
    v_sub_f32 v25, v20, v24
    v_fmac_f32 v27, v25, v25
    v_sub_f32 v25, v21, v24
    v_fmac_f32 v27, v25, v25
    v_sub_f32 v25, v22, v24
    v_fmac_f32 v27, v25, v25
    v_sub_f32 v25, v23, v24
    v_fmac_f32 v27, v25, v25
    s_nop 1
    v_add_f32_dpp v27, v27, v27 quad_perm:[1,0,3,2] row_mask:0xf bank_mask:0xf
    s_nop 1
    v_add_f32_dpp v27, v27, v27 quad_perm:[2,3,0,1] row_mask:0xf bank_mask:0xf
    s_nop 1
    v_add_f32_dpp v27, v27, v27 row_half_mirror row_mask:0xf bank_mask:0xf
    s_nop 1
    v_add_f32_dpp v27, v27, v27 row_mirror row_mask:0xf bank_mask:0xf
    v_mov_b32 v25, v27
    s_nop 1
    v_permlane16_swap_b32 v27, v25
    s_nop 1
    v_add_f32 v27, v27, v25
    v_mov_b32 v25, v27
    s_nop 1
    v_permlane32_swap_b32 v27, v25
    s_nop 1
    v_add_f32 v27, v27, v25
    v_mul_f32 v27, s33, v27
    v_cvt_pk_bf16_f32 v27, v27, v27
    v_lshlrev_b32 v27, 16, v27
    v_add_f32 v27, 0x3727c5ac, v27
    v_cvt_pk_bf16_f32 v27, v27, v27
    v_lshlrev_b32 v27, 16, v27
    v_sqrt_f32 v27, v27
    s_nop 0
    v_cvt_pk_bf16_f32 v27, v27, v27
    v_lshlrev_b32 v27, 16, v27
    v_cvt_pk_bf16_f32 v24, v24, v24
    v_lshlrev_b32 v24, 16, v24
    s_waitcnt vmcnt(4)
    v_lshlrev_b32 v16, 16, v12
    v_and_b32 v17, 0xffff0000, v12
    v_lshlrev_b32 v18, 16, v13
    v_and_b32 v19, 0xffff0000, v13
    v_sub_f32 v16, v16, v24
    v_cvt_pk_bf16_f32 v16, v16, v16
    v_lshlrev_b32 v16, 16, v16
    v_rcp_f32 v28, v27
    s_nop 0
    v_mul_f32 v29, v16, v28
    v_fma_f32 v30, -v29, v27, v16
    v_fma_f32 v16, v30, v28, v29
    v_cvt_pk_bf16_f32 v16, v16, v16
    v_lshlrev_b32 v16, 16, v16
    v_sub_f32 v17, v17, v24
    v_cvt_pk_bf16_f32 v17, v17, v17
    v_lshlrev_b32 v17, 16, v17
    v_rcp_f32 v28, v27
    s_nop 0
    v_mul_f32 v29, v17, v28
    v_fma_f32 v30, -v29, v27, v17
    v_fma_f32 v17, v30, v28, v29
    v_cvt_pk_bf16_f32 v17, v17, v17
    v_lshlrev_b32 v17, 16, v17
    v_sub_f32 v18, v18, v24
    v_cvt_pk_bf16_f32 v18, v18, v18
    v_lshlrev_b32 v18, 16, v18
    v_rcp_f32 v28, v27
    s_nop 0
    v_mul_f32 v29, v18, v28
    v_fma_f32 v30, -v29, v27, v18
    v_fma_f32 v18, v30, v28, v29
    v_cvt_pk_bf16_f32 v18, v18, v18
    v_lshlrev_b32 v18, 16, v18
    v_sub_f32 v19, v19, v24
    v_cvt_pk_bf16_f32 v19, v19, v19
    v_lshlrev_b32 v19, 16, v19
    v_rcp_f32 v28, v27
    s_nop 0
    v_mul_f32 v29, v19, v28
    v_fma_f32 v30, -v29, v27, v19
    v_fma_f32 v19, v30, v28, v29
    v_cvt_pk_bf16_f32 v19, v19, v19
    v_lshlrev_b32 v19, 16, v19
    v_mov_b32 v64, 0
    v_mov_b32 v65, 0
    v_mov_b32 v66, 0
    v_mov_b32 v67, 0
    v_mov_b32 v68, 0
    v_mov_b32 v69, 0
    v_mov_b32 v70, 0
    v_mov_b32 v71, 0
    s_waitcnt vmcnt(3)
    v_lshlrev_b32 v28, 16, v32
    v_and_b32 v29, 0xffff0000, v32
    v_fmac_f32 v64, v16, v28
    v_fmac_f32 v65, v16, v29
    v_lshlrev_b32 v28, 16, v33
    v_and_b32 v29, 0xffff0000, v33
    v_fmac_f32 v66, v16, v28
    v_fmac_f32 v67, v16, v29
    v_lshlrev_b32 v28, 16, v34
    v_and_b32 v29, 0xffff0000, v34
    v_fmac_f32 v68, v16, v28
    v_fmac_f32 v69, v16, v29
    v_lshlrev_b32 v28, 16, v35
    v_and_b32 v29, 0xffff0000, v35
    v_fmac_f32 v70, v16, v28
    v_fmac_f32 v71, v16, v29
    s_waitcnt vmcnt(2)
    v_lshlrev_b32 v28, 16, v36
    v_and_b32 v29, 0xffff0000, v36
    v_fmac_f32 v64, v17, v28
    v_fmac_f32 v65, v17, v29
    v_lshlrev_b32 v28, 16, v37
    v_and_b32 v29, 0xffff0000, v37
    v_fmac_f32 v66, v17, v28
    v_fmac_f32 v67, v17, v29
    v_lshlrev_b32 v28, 16, v38
    v_and_b32 v29, 0xffff0000, v38
    v_fmac_f32 v68, v17, v28
    v_fmac_f32 v69, v17, v29
    v_lshlrev_b32 v28, 16, v39
    v_and_b32 v29, 0xffff0000, v39
    v_fmac_f32 v70, v17, v28
    v_fmac_f32 v71, v17, v29
    s_waitcnt vmcnt(1)
    v_lshlrev_b32 v28, 16, v40
    v_and_b32 v29, 0xffff0000, v40
    v_fmac_f32 v64, v18, v28
    v_fmac_f32 v65, v18, v29
    v_lshlrev_b32 v28, 16, v41
    v_and_b32 v29, 0xffff0000, v41
    v_fmac_f32 v66, v18, v28
    v_fmac_f32 v67, v18, v29
    v_lshlrev_b32 v28, 16, v42
    v_and_b32 v29, 0xffff0000, v42
    v_fmac_f32 v68, v18, v28
    v_fmac_f32 v69, v18, v29
    v_lshlrev_b32 v28, 16, v43
    v_and_b32 v29, 0xffff0000, v43
    v_fmac_f32 v70, v18, v28
    v_fmac_f32 v71, v18, v29
    s_waitcnt vmcnt(0)
    v_lshlrev_b32 v28, 16, v44
    v_and_b32 v29, 0xffff0000, v44
    v_fmac_f32 v64, v19, v28
    v_fmac_f32 v65, v19, v29
    v_lshlrev_b32 v28, 16, v45
    v_and_b32 v29, 0xffff0000, v45
    v_fmac_f32 v66, v19, v28
    v_fmac_f32 v67, v19, v29
    v_lshlrev_b32 v28, 16, v46
    v_and_b32 v29, 0xffff0000, v46
    v_fmac_f32 v68, v19, v28
    v_fmac_f32 v69, v19, v29
    v_lshlrev_b32 v28, 16, v47
    v_and_b32 v29, 0xffff0000, v47
    v_fmac_f32 v70, v19, v28
    v_fmac_f32 v71, v19, v29
    s_nop 1
    v_add_f32_dpp v64, v64, v64 row_ror:4 row_mask:0xf bank_mask:0xf
    s_nop 1
    v_add_f32_dpp v64, v64, v64 row_ror:8 row_mask:0xf bank_mask:0xf
    v_mov_b32 v28, v64
    s_nop 1
    v_permlane16_swap_b32 v64, v28
    s_nop 1
    v_add_f32 v64, v64, v28
    v_mov_b32 v28, v64
    s_nop 1
    v_permlane32_swap_b32 v64, v28
    s_nop 1
    v_add_f32 v64, v64, v28
    s_nop 1
    v_add_f32_dpp v65, v65, v65 row_ror:4 row_mask:0xf bank_mask:0xf
    s_nop 1
    v_add_f32_dpp v65, v65, v65 row_ror:8 row_mask:0xf bank_mask:0xf
    v_mov_b32 v28, v65
    s_nop 1
    v_permlane16_swap_b32 v65, v28
    s_nop 1
    v_add_f32 v65, v65, v28
    v_mov_b32 v28, v65
    s_nop 1
    v_permlane32_swap_b32 v65, v28
    s_nop 1
    v_add_f32 v65, v65, v28
    s_nop 1
    v_add_f32_dpp v66, v66, v66 row_ror:4 row_mask:0xf bank_mask:0xf
    s_nop 1
    v_add_f32_dpp v66, v66, v66 row_ror:8 row_mask:0xf bank_mask:0xf
    v_mov_b32 v28, v66
    s_nop 1
    v_permlane16_swap_b32 v66, v28
    s_nop 1
    v_add_f32 v66, v66, v28
    v_mov_b32 v28, v66
    s_nop 1
    v_permlane32_swap_b32 v66, v28
    s_nop 1
    v_add_f32 v66, v66, v28
    s_nop 1
    v_add_f32_dpp v67, v67, v67 row_ror:4 row_mask:0xf bank_mask:0xf
    s_nop 1
    v_add_f32_dpp v67, v67, v67 row_ror:8 row_mask:0xf bank_mask:0xf
    v_mov_b32 v28, v67
    s_nop 1
    v_permlane16_swap_b32 v67, v28
    s_nop 1
    v_add_f32 v67, v67, v28
    v_mov_b32 v28, v67
    s_nop 1
    v_permlane32_swap_b32 v67, v28
    s_nop 1
    v_add_f32 v67, v67, v28
    s_nop 1
    v_add_f32_dpp v68, v68, v68 row_ror:4 row_mask:0xf bank_mask:0xf
    s_nop 1
    v_add_f32_dpp v68, v68, v68 row_ror:8 row_mask:0xf bank_mask:0xf
    v_mov_b32 v28, v68
    s_nop 1
    v_permlane16_swap_b32 v68, v28
    s_nop 1
    v_add_f32 v68, v68, v28
    v_mov_b32 v28, v68
    s_nop 1
    v_permlane32_swap_b32 v68, v28
    s_nop 1
    v_add_f32 v68, v68, v28
    s_nop 1
    v_add_f32_dpp v69, v69, v69 row_ror:4 row_mask:0xf bank_mask:0xf
    s_nop 1
    v_add_f32_dpp v69, v69, v69 row_ror:8 row_mask:0xf bank_mask:0xf
    v_mov_b32 v28, v69
    s_nop 1
    v_permlane16_swap_b32 v69, v28
    s_nop 1
    v_add_f32 v69, v69, v28
    v_mov_b32 v28, v69
    s_nop 1
    v_permlane32_swap_b32 v69, v28
    s_nop 1
    v_add_f32 v69, v69, v28
    s_nop 1
    v_add_f32_dpp v70, v70, v70 row_ror:4 row_mask:0xf bank_mask:0xf
    s_nop 1
    v_add_f32_dpp v70, v70, v70 row_ror:8 row_mask:0xf bank_mask:0xf
    v_mov_b32 v28, v70
    s_nop 1
    v_permlane16_swap_b32 v70, v28
    s_nop 1
    v_add_f32 v70, v70, v28
    v_mov_b32 v28, v70
    s_nop 1
    v_permlane32_swap_b32 v70, v28
    s_nop 1
    v_add_f32 v70, v70, v28
    s_nop 1
    v_add_f32_dpp v71, v71, v71 row_ror:4 row_mask:0xf bank_mask:0xf
    s_nop 1
    v_add_f32_dpp v71, v71, v71 row_ror:8 row_mask:0xf bank_mask:0xf
    v_mov_b32 v28, v71
    s_nop 1
    v_permlane16_swap_b32 v71, v28
    s_nop 1
    v_add_f32 v71, v71, v28
    v_mov_b32 v28, v71
    s_nop 1
    v_permlane32_swap_b32 v71, v28
    s_nop 1
    v_add_f32 v71, v71, v28
    v_lshlrev_b32 v6, 7, v3
    v_lshl_add_u32 v6, v7, 5, v6
    v_and_b32 v8, 63, v0
    v_cmp_gt_u32 vcc, 4, v8
    s_and_saveexec_b64 s[52:53], vcc
    ds_write_b128 v6, v[64:67] offset:17920
    ds_write_b128 v6, v[68:71] offset:17936
    s_mov_b64 exec, s[52:53]
    s_waitcnt lgkmcnt(0)
    s_barrier
    s_cmp_lg_u32 s3, 0
    s_cbranch_scc1 pro_done
    v_lshlrev_b32 v6, 3, v0
    ds_read_b64 v[10:11], v6 offset:17920
    ds_read_b64 v[12:13], v6 offset:18048
    ds_read_b64 v[14:15], v6 offset:18176
    ds_read_b64 v[16:17], v6 offset:18304
    ds_read_b64 v[18:19], v6 offset:18432
    ds_read_b64 v[20:21], v6 offset:18560
    ds_read_b64 v[22:23], v6 offset:18688
    ds_read_b64 v[24:25], v6 offset:18816
    s_mov_b32 s50, 0
    v_mov_b32 v9, 0
tq_loop:
    global_load_dword v8, v9, s[86:87] sc1
    s_waitcnt vmcnt(0)
    v_readfirstlane_b32 s34, v8
    s_add_u32 s50, s50, 1
    s_cmp_lg_u32 s34, 0
    s_cbranch_scc1 tq_done
    s_cmp_lt_u32 s50, 400000
    s_cbranch_scc1 tq_loop
tq_done:
    s_waitcnt lgkmcnt(0)
    v_add_f32 v10, v10, v12
    v_add_f32 v14, v14, v16
    v_add_f32 v18, v18, v20
    v_add_f32 v22, v22, v24
    v_add_f32 v10, v10, v14
    v_add_f32 v18, v18, v22
    v_add_f32 v10, v10, v18
    v_add_f32 v11, v11, v13
    v_add_f32 v15, v15, v17
    v_add_f32 v19, v19, v21
    v_add_f32 v23, v23, v25
    v_add_f32 v11, v11, v15
    v_add_f32 v19, v19, v23
    v_add_f32 v11, v11, v19
    v_cvt_pk_bf16_f32 v10, v10, v11
    v_mov_b32 v11, s34
    s_lshl_b32 s12, s14, 7
    v_cmp_gt_u32 vcc, 16, v0
    s_and_saveexec_b64 s[52:53], vcc
    s_add_u32 s12, s12, 16384
    buffer_store_dwordx2 v[10:11], v6, s[24:27], s12 offen sc1
    s_mov_b64 exec, s[52:53]
pro_done:
    s_cmp_eq_u32 s3, 0
    s_cbranch_scc1 att_w0
    buffer_load_dwordx4 v[32:35], v4, s[16:19], s40 offen offset:0 nt
    buffer_load_dwordx4 v[36:39], v4, s[16:19], s40 offen offset:64 nt
    buffer_load_dwordx4 v[40:43], v4, s[16:19], s40 offen offset:128 nt
    buffer_load_dwordx4 v[44:47], v4, s[16:19], s40 offen offset:192 nt
    buffer_load_dwordx4 v[48:51], v4, s[16:19], s40 offen offset:1024 nt
    buffer_load_dwordx4 v[52:55], v4, s[16:19], s40 offen offset:1088 nt
    buffer_load_dwordx4 v[56:59], v4, s[16:19], s40 offen offset:1152 nt
    buffer_load_dwordx4 v[60:63], v4, s[16:19], s40 offen offset:1216 nt
    buffer_load_dwordx4 v[96:99], v5, s[20:23], s40 offen offset:0 nt
    buffer_load_dwordx4 v[100:103], v5, s[20:23], s40 offen offset:256 nt
    buffer_load_dwordx4 v[104:107], v5, s[20:23], s40 offen offset:512 nt
    buffer_load_dwordx4 v[108:111], v5, s[20:23], s40 offen offset:768 nt
    buffer_load_dwordx4 v[112:115], v5, s[20:23], s40 offen offset:1024 nt
    buffer_load_dwordx4 v[116:119], v5, s[20:23], s40 offen offset:1280 nt
    buffer_load_dwordx4 v[120:123], v5, s[20:23], s40 offen offset:1536 nt
    buffer_load_dwordx4 v[124:127], v5, s[20:23], s40 offen offset:1792 nt
    buffer_load_dwordx4 v[64:67], v4, s[16:19], s41 offen offset:0 nt
    buffer_load_dwordx4 v[68:71], v4, s[16:19], s41 offen offset:64 nt
    buffer_load_dwordx4 v[72:75], v4, s[16:19], s41 offen offset:128 nt
    buffer_load_dwordx4 v[76:79], v4, s[16:19], s41 offen offset:192 nt
    buffer_load_dwordx4 v[80:83], v4, s[16:19], s41 offen offset:1024 nt
    buffer_load_dwordx4 v[84:87], v4, s[16:19], s41 offen offset:1088 nt
    buffer_load_dwordx4 v[88:91], v4, s[16:19], s41 offen offset:1152 nt
    buffer_load_dwordx4 v[92:95], v4, s[16:19], s41 offen offset:1216 nt
    buffer_load_dwordx4 v[128:131], v5, s[20:23], s41 offen offset:0 nt
    buffer_load_dwordx4 v[132:135], v5, s[20:23], s41 offen offset:256 nt
    buffer_load_dwordx4 v[136:139], v5, s[20:23], s41 offen offset:512 nt
    buffer_load_dwordx4 v[140:143], v5, s[20:23], s41 offen offset:768 nt
    buffer_load_dwordx4 v[144:147], v5, s[20:23], s41 offen offset:1024 nt
    buffer_load_dwordx4 v[148:151], v5, s[20:23], s41 offen offset:1280 nt
    buffer_load_dwordx4 v[152:155], v5, s[20:23], s41 offen offset:1536 nt
    buffer_load_dwordx4 v[156:159], v5, s[20:23], s41 offen offset:1792 nt
    s_barrier
    s_branch att_common
att_w0:
    s_mov_b32 s50, 0
    v_mov_b32 v9, 0
tc_loop:
    global_load_dword v8, v9, s[86:87] sc1
    s_waitcnt vmcnt(0)
    v_readfirstlane_b32 s34, v8
    s_add_u32 s50, s50, 1
    s_cmp_lg_u32 s34, 0
    s_cbranch_scc1 tc_done
    s_cmp_lt_u32 s50, 400000
    s_cbranch_scc1 tc_loop
tc_done:
    v_lshlrev_b32 v6, 5, v0
    s_lshl_b32 s12, s10, 11
    s_add_u32 s12, s12, 16384
    v_mov_b32 v7, s34
    s_mov_b32 s50, 0
qp_loop:
    buffer_load_dwordx4 v[8:11], v6, s[24:27], s12 offen sc1
    buffer_load_dwordx4 v[12:15], v6, s[24:27], s12 offen offset:16 sc1
    s_waitcnt vmcnt(0)
    v_cmp_eq_u32 vcc, v9, v7
    v_cmp_eq_u32 s[52:53], v11, v7
    s_and_b64 vcc, vcc, s[52:53]
    v_cmp_eq_u32 s[52:53], v13, v7
    s_and_b64 vcc, vcc, s[52:53]
    v_cmp_eq_u32 s[52:53], v15, v7
    s_and_b64 vcc, vcc, s[52:53]
    s_add_u32 s50, s50, 1
    s_cmp_eq_u64 vcc, exec
    s_cbranch_scc1 qp_done
    s_cmp_lt_u32 s50, 400000
    s_cbranch_scc1 qp_loop
qp_done:
    v_mov_b32 v9, v10
    v_mov_b32 v10, v12
    v_mov_b32 v11, v14
    v_lshlrev_b32 v6, 4, v0
    ds_write_b128 v6, v[8:11] offset:16640
    s_waitcnt lgkmcnt(0)
    s_barrier
    buffer_load_dwordx4 v[32:35], v4, s[16:19], s40 offen offset:0 nt
    buffer_load_dwordx4 v[36:39], v4, s[16:19], s40 offen offset:64 nt
    buffer_load_dwordx4 v[40:43], v4, s[16:19], s40 offen offset:128 nt
    buffer_load_dwordx4 v[44:47], v4, s[16:19], s40 offen offset:192 nt
    buffer_load_dwordx4 v[48:51], v4, s[16:19], s40 offen offset:1024 nt
    buffer_load_dwordx4 v[52:55], v4, s[16:19], s40 offen offset:1088 nt
    buffer_load_dwordx4 v[56:59], v4, s[16:19], s40 offen offset:1152 nt
    buffer_load_dwordx4 v[60:63], v4, s[16:19], s40 offen offset:1216 nt
    buffer_load_dwordx4 v[96:99], v5, s[20:23], s40 offen offset:0 nt
    buffer_load_dwordx4 v[100:103], v5, s[20:23], s40 offen offset:256 nt
    buffer_load_dwordx4 v[104:107], v5, s[20:23], s40 offen offset:512 nt
    buffer_load_dwordx4 v[108:111], v5, s[20:23], s40 offen offset:768 nt
    buffer_load_dwordx4 v[112:115], v5, s[20:23], s40 offen offset:1024 nt
    buffer_load_dwordx4 v[116:119], v5, s[20:23], s40 offen offset:1280 nt
    buffer_load_dwordx4 v[120:123], v5, s[20:23], s40 offen offset:1536 nt
    buffer_load_dwordx4 v[124:127], v5, s[20:23], s40 offen offset:1792 nt
    buffer_load_dwordx4 v[64:67], v4, s[16:19], s41 offen offset:0 nt
    buffer_load_dwordx4 v[68:71], v4, s[16:19], s41 offen offset:64 nt
    buffer_load_dwordx4 v[72:75], v4, s[16:19], s41 offen offset:128 nt
    buffer_load_dwordx4 v[76:79], v4, s[16:19], s41 offen offset:192 nt
    buffer_load_dwordx4 v[80:83], v4, s[16:19], s41 offen offset:1024 nt
    buffer_load_dwordx4 v[84:87], v4, s[16:19], s41 offen offset:1088 nt
    buffer_load_dwordx4 v[88:91], v4, s[16:19], s41 offen offset:1152 nt
    buffer_load_dwordx4 v[92:95], v4, s[16:19], s41 offen offset:1216 nt
    buffer_load_dwordx4 v[128:131], v5, s[20:23], s41 offen offset:0 nt
    buffer_load_dwordx4 v[132:135], v5, s[20:23], s41 offen offset:256 nt
    buffer_load_dwordx4 v[136:139], v5, s[20:23], s41 offen offset:512 nt
    buffer_load_dwordx4 v[140:143], v5, s[20:23], s41 offen offset:768 nt
    buffer_load_dwordx4 v[144:147], v5, s[20:23], s41 offen offset:1024 nt
    buffer_load_dwordx4 v[148:151], v5, s[20:23], s41 offen offset:1280 nt
    buffer_load_dwordx4 v[152:155], v5, s[20:23], s41 offen offset:1536 nt
    buffer_load_dwordx4 v[156:159], v5, s[20:23], s41 offen offset:1792 nt
att_common:
    v_mov_b32 v16, 0
    v_mov_b32 v17, 0
    v_mov_b32 v18, 0
    v_mov_b32 v19, 0
    v_mov_b32 v20, 0
    v_mov_b32 v21, 0
    v_mov_b32 v22, 0
    v_mov_b32 v23, 0
    v_mov_b32 v24, 0
    v_mov_b32 v25, 0
    v_mov_b32 v26, 0
    v_mov_b32 v27, 0
    v_mov_b32 v28, 0
    v_mov_b32 v29, 0
    v_mov_b32 v30, 0
    v_mov_b32 v31, 0
    v_lshlrev_b32 v6, 8, v1
    v_lshl_add_u32 v6, v2, 4, v6
    v_cmp_gt_u32 vcc, 4, v1
    s_and_saveexec_b64 s[52:53], vcc
    ds_read_b128 v[16:19], v6 offset:16640
    ds_read_b128 v[20:23], v6 offset:16704
    ds_read_b128 v[24:27], v6 offset:16768
    ds_read_b128 v[28:31], v6 offset:16832
    s_mov_b64 exec, s[52:53]
    v_mov_b32 v236, 0xff800000
    v_mov_b32 v237, 0
    v_mov_b32 v192, 0
    v_mov_b32 v193, 0
    v_mov_b32 v194, 0
    v_mov_b32 v195, 0
    v_mov_b32 v196, 0
    v_mov_b32 v197, 0
    v_mov_b32 v198, 0
    v_mov_b32 v199, 0
    v_mov_b32 v200, 0
    v_mov_b32 v201, 0
    v_mov_b32 v202, 0
    v_mov_b32 v203, 0
    v_mov_b32 v204, 0
    v_mov_b32 v205, 0
    v_mov_b32 v206, 0
    v_mov_b32 v207, 0
    v_mov_b32 v208, 0
    v_mov_b32 v209, 0
    v_mov_b32 v210, 0
    v_mov_b32 v211, 0
    v_mov_b32 v212, 0
    v_mov_b32 v213, 0
    v_mov_b32 v214, 0
    v_mov_b32 v215, 0
    v_mov_b32 v216, 0
    v_mov_b32 v217, 0
    v_mov_b32 v218, 0
    v_mov_b32 v219, 0
    v_mov_b32 v220, 0
    v_mov_b32 v221, 0
    v_mov_b32 v222, 0
    v_mov_b32 v223, 0
    s_waitcnt lgkmcnt(0)
    s_waitcnt vmcnt(24)
    v_mfma_f32_16x16x32_bf16 v[224:227], v[32:35], v[16:19], 0
    v_mfma_f32_16x16x32_bf16 v[224:227], v[36:39], v[20:23], v[224:227]
    v_mfma_f32_16x16x32_bf16 v[224:227], v[40:43], v[24:27], v[224:227]
    v_mfma_f32_16x16x32_bf16 v[224:227], v[44:47], v[28:31], v[224:227]
    v_mfma_f32_16x16x32_bf16 v[228:231], v[48:51], v[16:19], 0
    v_mfma_f32_16x16x32_bf16 v[228:231], v[52:55], v[20:23], v[228:231]
    v_mfma_f32_16x16x32_bf16 v[228:231], v[56:59], v[24:27], v[228:231]
    v_mfma_f32_16x16x32_bf16 v[228:231], v[60:63], v[28:31], v[228:231]
    buffer_load_dwordx4 v[32:35], v4, s[16:19], s42 offen offset:0 nt
    buffer_load_dwordx4 v[36:39], v4, s[16:19], s42 offen offset:64 nt
    buffer_load_dwordx4 v[40:43], v4, s[16:19], s42 offen offset:128 nt
    buffer_load_dwordx4 v[44:47], v4, s[16:19], s42 offen offset:192 nt
    buffer_load_dwordx4 v[48:51], v4, s[16:19], s42 offen offset:1024 nt
    buffer_load_dwordx4 v[52:55], v4, s[16:19], s42 offen offset:1088 nt
    buffer_load_dwordx4 v[56:59], v4, s[16:19], s42 offen offset:1152 nt
    buffer_load_dwordx4 v[60:63], v4, s[16:19], s42 offen offset:1216 nt
    s_nop 7
    s_nop 3
    v_cvt_pk_bf16_f32 v239, v224, v225
    v_lshlrev_b32 v224, 16, v239
    v_and_b32 v225, 0xffff0000, v239
    v_mul_f32 v224, s30, v224
    v_mul_f32 v225, s30, v225
    v_cvt_pk_bf16_f32 v239, v224, v225
    v_lshlrev_b32 v224, 16, v239
    v_and_b32 v225, 0xffff0000, v239
    v_cvt_pk_bf16_f32 v239, v226, v227
    v_lshlrev_b32 v226, 16, v239
    v_and_b32 v227, 0xffff0000, v239
    v_mul_f32 v226, s30, v226
    v_mul_f32 v227, s30, v227
    v_cvt_pk_bf16_f32 v239, v226, v227
    v_lshlrev_b32 v226, 16, v239
    v_and_b32 v227, 0xffff0000, v239
    v_cvt_pk_bf16_f32 v239, v228, v229
    v_lshlrev_b32 v228, 16, v239
    v_and_b32 v229, 0xffff0000, v239
    v_mul_f32 v228, s30, v228
    v_mul_f32 v229, s30, v229
    v_cvt_pk_bf16_f32 v239, v228, v229
    v_lshlrev_b32 v228, 16, v239
    v_and_b32 v229, 0xffff0000, v239
    v_cvt_pk_bf16_f32 v239, v230, v231
    v_lshlrev_b32 v230, 16, v239
    v_and_b32 v231, 0xffff0000, v239
    v_mul_f32 v230, s30, v230
    v_mul_f32 v231, s30, v231
    v_cvt_pk_bf16_f32 v239, v230, v231
    v_lshlrev_b32 v230, 16, v239
    v_and_b32 v231, 0xffff0000, v239
    v_max3_f32 v239, v224, v225, v226
    v_max3_f32 v239, v239, v227, v228
    v_max3_f32 v239, v239, v229, v230
    v_max_f32 v239, v239, v231
    v_mov_b32 v240, v239
    s_nop 1
    v_permlane16_swap_b32 v239, v240
    s_nop 1
    v_max_f32 v239, v239, v240
    v_mov_b32 v240, v239
    s_nop 1
    v_permlane32_swap_b32 v239, v240
    s_nop 1
    v_max3_f32 v243, v239, v240, v236
    v_sub_f32 v238, v236, v243
    v_mul_f32 v238, s31, v238
    v_exp_f32 v238, v238
    v_mov_b32 v236, v243
    v_mul_f32 v241, s31, v243
    v_fma_f32 v224, v224, s31, -v241
    v_fma_f32 v225, v225, s31, -v241
    v_fma_f32 v226, v226, s31, -v241
    v_fma_f32 v227, v227, s31, -v241
    v_fma_f32 v228, v228, s31, -v241
    v_fma_f32 v229, v229, s31, -v241
    v_fma_f32 v230, v230, s31, -v241
    v_fma_f32 v231, v231, s31, -v241
    v_exp_f32 v224, v224
    v_exp_f32 v225, v225
    v_exp_f32 v226, v226
    v_exp_f32 v227, v227
    v_exp_f32 v228, v228
    v_exp_f32 v229, v229
    v_exp_f32 v230, v230
    v_exp_f32 v231, v231
    s_nop 0
    v_add_f32 v239, v224, v225
    v_add_f32 v240, v226, v227
    v_add_f32 v241, v228, v229
    v_add_f32 v242, v230, v231
    v_add_f32 v239, v239, v240
    v_add_f32 v241, v241, v242
    v_add_f32 v239, v239, v241
    v_fma_f32 v237, v237, v238, v239
    v_cvt_pk_bf16_f32 v232, v224, v225
    v_cvt_pk_bf16_f32 v233, v226, v227
    v_cvt_pk_bf16_f32 v234, v228, v229
    v_cvt_pk_bf16_f32 v235, v230, v231
    v_mul_f32 v192, v238, v192
    v_mul_f32 v193, v238, v193
    v_mul_f32 v194, v238, v194
    v_mul_f32 v195, v238, v195
    v_mul_f32 v196, v238, v196
    v_mul_f32 v197, v238, v197
    v_mul_f32 v198, v238, v198
    v_mul_f32 v199, v238, v199
    v_mul_f32 v200, v238, v200
    v_mul_f32 v201, v238, v201
    v_mul_f32 v202, v238, v202
    v_mul_f32 v203, v238, v203
    v_mul_f32 v204, v238, v204
    v_mul_f32 v205, v238, v205
    v_mul_f32 v206, v238, v206
    v_mul_f32 v207, v238, v207
    v_mul_f32 v208, v238, v208
    v_mul_f32 v209, v238, v209
    v_mul_f32 v210, v238, v210
    v_mul_f32 v211, v238, v211
    v_mul_f32 v212, v238, v212
    v_mul_f32 v213, v238, v213
    v_mul_f32 v214, v238, v214
    v_mul_f32 v215, v238, v215
    v_mul_f32 v216, v238, v216
    v_mul_f32 v217, v238, v217
    v_mul_f32 v218, v238, v218
    v_mul_f32 v219, v238, v219
    v_mul_f32 v220, v238, v220
    v_mul_f32 v221, v238, v221
    v_mul_f32 v222, v238, v222
    v_mul_f32 v223, v238, v223
    s_waitcnt vmcnt(24)
    v_perm_b32 v160, v100, v96, s28
    v_perm_b32 v164, v100, v96, s29
    v_perm_b32 v161, v108, v104, s28
    v_perm_b32 v165, v108, v104, s29
    v_perm_b32 v162, v116, v112, s28
    v_perm_b32 v166, v116, v112, s29
    v_perm_b32 v163, v124, v120, s28
    v_perm_b32 v167, v124, v120, s29
    v_perm_b32 v168, v101, v97, s28
    v_perm_b32 v172, v101, v97, s29
    v_perm_b32 v169, v109, v105, s28
    v_perm_b32 v173, v109, v105, s29
    v_perm_b32 v170, v117, v113, s28
    v_perm_b32 v174, v117, v113, s29
    v_perm_b32 v171, v125, v121, s28
    v_perm_b32 v175, v125, v121, s29
    v_perm_b32 v176, v102, v98, s28
    v_perm_b32 v180, v102, v98, s29
    v_perm_b32 v177, v110, v106, s28
    v_perm_b32 v181, v110, v106, s29
    v_perm_b32 v178, v118, v114, s28
    v_perm_b32 v182, v118, v114, s29
    v_perm_b32 v179, v126, v122, s28
    v_perm_b32 v183, v126, v122, s29
    v_perm_b32 v184, v103, v99, s28
    v_perm_b32 v188, v103, v99, s29
    v_perm_b32 v185, v111, v107, s28
    v_perm_b32 v189, v111, v107, s29
    v_perm_b32 v186, v119, v115, s28
    v_perm_b32 v190, v119, v115, s29
    v_perm_b32 v187, v127, v123, s28
    v_perm_b32 v191, v127, v123, s29
    s_nop 1
    v_mfma_f32_16x16x32_bf16 v[192:195], v[160:163], v[232:235], v[192:195]
    v_mfma_f32_16x16x32_bf16 v[196:199], v[164:167], v[232:235], v[196:199]
    v_mfma_f32_16x16x32_bf16 v[200:203], v[168:171], v[232:235], v[200:203]
    v_mfma_f32_16x16x32_bf16 v[204:207], v[172:175], v[232:235], v[204:207]
    v_mfma_f32_16x16x32_bf16 v[208:211], v[176:179], v[232:235], v[208:211]
    v_mfma_f32_16x16x32_bf16 v[212:215], v[180:183], v[232:235], v[212:215]
    v_mfma_f32_16x16x32_bf16 v[216:219], v[184:187], v[232:235], v[216:219]
    v_mfma_f32_16x16x32_bf16 v[220:223], v[188:191], v[232:235], v[220:223]
    buffer_load_dwordx4 v[96:99], v5, s[20:23], s42 offen offset:0 nt
    buffer_load_dwordx4 v[100:103], v5, s[20:23], s42 offen offset:256 nt
    buffer_load_dwordx4 v[104:107], v5, s[20:23], s42 offen offset:512 nt
    buffer_load_dwordx4 v[108:111], v5, s[20:23], s42 offen offset:768 nt
    buffer_load_dwordx4 v[112:115], v5, s[20:23], s42 offen offset:1024 nt
    buffer_load_dwordx4 v[116:119], v5, s[20:23], s42 offen offset:1280 nt
    buffer_load_dwordx4 v[120:123], v5, s[20:23], s42 offen offset:1536 nt
    buffer_load_dwordx4 v[124:127], v5, s[20:23], s42 offen offset:1792 nt
    s_nop 7
    s_nop 3
    s_waitcnt vmcnt(24)
    v_mfma_f32_16x16x32_bf16 v[224:227], v[64:67], v[16:19], 0
    v_mfma_f32_16x16x32_bf16 v[224:227], v[68:71], v[20:23], v[224:227]
    v_mfma_f32_16x16x32_bf16 v[224:227], v[72:75], v[24:27], v[224:227]
    v_mfma_f32_16x16x32_bf16 v[224:227], v[76:79], v[28:31], v[224:227]
    v_mfma_f32_16x16x32_bf16 v[228:231], v[80:83], v[16:19], 0
    v_mfma_f32_16x16x32_bf16 v[228:231], v[84:87], v[20:23], v[228:231]
    v_mfma_f32_16x16x32_bf16 v[228:231], v[88:91], v[24:27], v[228:231]
    v_mfma_f32_16x16x32_bf16 v[228:231], v[92:95], v[28:31], v[228:231]
    buffer_load_dwordx4 v[64:67], v4, s[16:19], s43 offen offset:0 nt
    buffer_load_dwordx4 v[68:71], v4, s[16:19], s43 offen offset:64 nt
    buffer_load_dwordx4 v[72:75], v4, s[16:19], s43 offen offset:128 nt
    buffer_load_dwordx4 v[76:79], v4, s[16:19], s43 offen offset:192 nt
    buffer_load_dwordx4 v[80:83], v4, s[16:19], s43 offen offset:1024 nt
    buffer_load_dwordx4 v[84:87], v4, s[16:19], s43 offen offset:1088 nt
    buffer_load_dwordx4 v[88:91], v4, s[16:19], s43 offen offset:1152 nt
    buffer_load_dwordx4 v[92:95], v4, s[16:19], s43 offen offset:1216 nt
    s_nop 7
    s_nop 3
    v_cvt_pk_bf16_f32 v239, v224, v225
    v_lshlrev_b32 v224, 16, v239
    v_and_b32 v225, 0xffff0000, v239
    v_mul_f32 v224, s30, v224
    v_mul_f32 v225, s30, v225
    v_cvt_pk_bf16_f32 v239, v224, v225
    v_lshlrev_b32 v224, 16, v239
    v_and_b32 v225, 0xffff0000, v239
    v_cvt_pk_bf16_f32 v239, v226, v227
    v_lshlrev_b32 v226, 16, v239
    v_and_b32 v227, 0xffff0000, v239
    v_mul_f32 v226, s30, v226
    v_mul_f32 v227, s30, v227
    v_cvt_pk_bf16_f32 v239, v226, v227
    v_lshlrev_b32 v226, 16, v239
    v_and_b32 v227, 0xffff0000, v239
    v_cvt_pk_bf16_f32 v239, v228, v229
    v_lshlrev_b32 v228, 16, v239
    v_and_b32 v229, 0xffff0000, v239
    v_mul_f32 v228, s30, v228
    v_mul_f32 v229, s30, v229
    v_cvt_pk_bf16_f32 v239, v228, v229
    v_lshlrev_b32 v228, 16, v239
    v_and_b32 v229, 0xffff0000, v239
    v_cvt_pk_bf16_f32 v239, v230, v231
    v_lshlrev_b32 v230, 16, v239
    v_and_b32 v231, 0xffff0000, v239
    v_mul_f32 v230, s30, v230
    v_mul_f32 v231, s30, v231
    v_cvt_pk_bf16_f32 v239, v230, v231
    v_lshlrev_b32 v230, 16, v239
    v_and_b32 v231, 0xffff0000, v239
    v_max3_f32 v239, v224, v225, v226
    v_max3_f32 v239, v239, v227, v228
    v_max3_f32 v239, v239, v229, v230
    v_max_f32 v239, v239, v231
    v_mov_b32 v240, v239
    s_nop 1
    v_permlane16_swap_b32 v239, v240
    s_nop 1
    v_max_f32 v239, v239, v240
    v_mov_b32 v240, v239
    s_nop 1
    v_permlane32_swap_b32 v239, v240
    s_nop 1
    v_max3_f32 v243, v239, v240, v236
    v_sub_f32 v238, v236, v243
    v_mul_f32 v238, s31, v238
    v_exp_f32 v238, v238
    v_mov_b32 v236, v243
    v_mul_f32 v241, s31, v243
    v_fma_f32 v224, v224, s31, -v241
    v_fma_f32 v225, v225, s31, -v241
    v_fma_f32 v226, v226, s31, -v241
    v_fma_f32 v227, v227, s31, -v241
    v_fma_f32 v228, v228, s31, -v241
    v_fma_f32 v229, v229, s31, -v241
    v_fma_f32 v230, v230, s31, -v241
    v_fma_f32 v231, v231, s31, -v241
    v_exp_f32 v224, v224
    v_exp_f32 v225, v225
    v_exp_f32 v226, v226
    v_exp_f32 v227, v227
    v_exp_f32 v228, v228
    v_exp_f32 v229, v229
    v_exp_f32 v230, v230
    v_exp_f32 v231, v231
    s_nop 0
    v_add_f32 v239, v224, v225
    v_add_f32 v240, v226, v227
    v_add_f32 v241, v228, v229
    v_add_f32 v242, v230, v231
    v_add_f32 v239, v239, v240
    v_add_f32 v241, v241, v242
    v_add_f32 v239, v239, v241
    v_fma_f32 v237, v237, v238, v239
    v_cvt_pk_bf16_f32 v232, v224, v225
    v_cvt_pk_bf16_f32 v233, v226, v227
    v_cvt_pk_bf16_f32 v234, v228, v229
    v_cvt_pk_bf16_f32 v235, v230, v231
    v_mul_f32 v192, v238, v192
    v_mul_f32 v193, v238, v193
    v_mul_f32 v194, v238, v194
    v_mul_f32 v195, v238, v195
    v_mul_f32 v196, v238, v196
    v_mul_f32 v197, v238, v197
    v_mul_f32 v198, v238, v198
    v_mul_f32 v199, v238, v199
    v_mul_f32 v200, v238, v200
    v_mul_f32 v201, v238, v201
    v_mul_f32 v202, v238, v202
    v_mul_f32 v203, v238, v203
    v_mul_f32 v204, v238, v204
    v_mul_f32 v205, v238, v205
    v_mul_f32 v206, v238, v206
    v_mul_f32 v207, v238, v207
    v_mul_f32 v208, v238, v208
    v_mul_f32 v209, v238, v209
    v_mul_f32 v210, v238, v210
    v_mul_f32 v211, v238, v211
    v_mul_f32 v212, v238, v212
    v_mul_f32 v213, v238, v213
    v_mul_f32 v214, v238, v214
    v_mul_f32 v215, v238, v215
    v_mul_f32 v216, v238, v216
    v_mul_f32 v217, v238, v217
    v_mul_f32 v218, v238, v218
    v_mul_f32 v219, v238, v219
    v_mul_f32 v220, v238, v220
    v_mul_f32 v221, v238, v221
    v_mul_f32 v222, v238, v222
    v_mul_f32 v223, v238, v223
    s_waitcnt vmcnt(24)
    v_perm_b32 v160, v132, v128, s28
    v_perm_b32 v164, v132, v128, s29
    v_perm_b32 v161, v140, v136, s28
    v_perm_b32 v165, v140, v136, s29
    v_perm_b32 v162, v148, v144, s28
    v_perm_b32 v166, v148, v144, s29
    v_perm_b32 v163, v156, v152, s28
    v_perm_b32 v167, v156, v152, s29
    v_perm_b32 v168, v133, v129, s28
    v_perm_b32 v172, v133, v129, s29
    v_perm_b32 v169, v141, v137, s28
    v_perm_b32 v173, v141, v137, s29
    v_perm_b32 v170, v149, v145, s28
    v_perm_b32 v174, v149, v145, s29
    v_perm_b32 v171, v157, v153, s28
    v_perm_b32 v175, v157, v153, s29
    v_perm_b32 v176, v134, v130, s28
    v_perm_b32 v180, v134, v130, s29
    v_perm_b32 v177, v142, v138, s28
    v_perm_b32 v181, v142, v138, s29
    v_perm_b32 v178, v150, v146, s28
    v_perm_b32 v182, v150, v146, s29
    v_perm_b32 v179, v158, v154, s28
    v_perm_b32 v183, v158, v154, s29
    v_perm_b32 v184, v135, v131, s28
    v_perm_b32 v188, v135, v131, s29
    v_perm_b32 v185, v143, v139, s28
    v_perm_b32 v189, v143, v139, s29
    v_perm_b32 v186, v151, v147, s28
    v_perm_b32 v190, v151, v147, s29
    v_perm_b32 v187, v159, v155, s28
    v_perm_b32 v191, v159, v155, s29
    s_nop 1
    v_mfma_f32_16x16x32_bf16 v[192:195], v[160:163], v[232:235], v[192:195]
    v_mfma_f32_16x16x32_bf16 v[196:199], v[164:167], v[232:235], v[196:199]
    v_mfma_f32_16x16x32_bf16 v[200:203], v[168:171], v[232:235], v[200:203]
    v_mfma_f32_16x16x32_bf16 v[204:207], v[172:175], v[232:235], v[204:207]
    v_mfma_f32_16x16x32_bf16 v[208:211], v[176:179], v[232:235], v[208:211]
    v_mfma_f32_16x16x32_bf16 v[212:215], v[180:183], v[232:235], v[212:215]
    v_mfma_f32_16x16x32_bf16 v[216:219], v[184:187], v[232:235], v[216:219]
    v_mfma_f32_16x16x32_bf16 v[220:223], v[188:191], v[232:235], v[220:223]
    buffer_load_dwordx4 v[128:131], v5, s[20:23], s43 offen offset:0 nt
    buffer_load_dwordx4 v[132:135], v5, s[20:23], s43 offen offset:256 nt
    buffer_load_dwordx4 v[136:139], v5, s[20:23], s43 offen offset:512 nt
    buffer_load_dwordx4 v[140:143], v5, s[20:23], s43 offen offset:768 nt
    buffer_load_dwordx4 v[144:147], v5, s[20:23], s43 offen offset:1024 nt
    buffer_load_dwordx4 v[148:151], v5, s[20:23], s43 offen offset:1280 nt
    buffer_load_dwordx4 v[152:155], v5, s[20:23], s43 offen offset:1536 nt
    buffer_load_dwordx4 v[156:159], v5, s[20:23], s43 offen offset:1792 nt
    s_nop 7
    s_nop 3
    s_waitcnt vmcnt(24)
    v_mfma_f32_16x16x32_bf16 v[224:227], v[32:35], v[16:19], 0
    v_mfma_f32_16x16x32_bf16 v[224:227], v[36:39], v[20:23], v[224:227]
    v_mfma_f32_16x16x32_bf16 v[224:227], v[40:43], v[24:27], v[224:227]
    v_mfma_f32_16x16x32_bf16 v[224:227], v[44:47], v[28:31], v[224:227]
    v_mfma_f32_16x16x32_bf16 v[228:231], v[48:51], v[16:19], 0
    v_mfma_f32_16x16x32_bf16 v[228:231], v[52:55], v[20:23], v[228:231]
    v_mfma_f32_16x16x32_bf16 v[228:231], v[56:59], v[24:27], v[228:231]
    v_mfma_f32_16x16x32_bf16 v[228:231], v[60:63], v[28:31], v[228:231]
    buffer_load_dwordx4 v[32:35], v4, s[16:19], s44 offen offset:0 nt
    buffer_load_dwordx4 v[36:39], v4, s[16:19], s44 offen offset:64 nt
    buffer_load_dwordx4 v[40:43], v4, s[16:19], s44 offen offset:128 nt
    buffer_load_dwordx4 v[44:47], v4, s[16:19], s44 offen offset:192 nt
    buffer_load_dwordx4 v[48:51], v4, s[16:19], s44 offen offset:1024 nt
    buffer_load_dwordx4 v[52:55], v4, s[16:19], s44 offen offset:1088 nt
    buffer_load_dwordx4 v[56:59], v4, s[16:19], s44 offen offset:1152 nt
    buffer_load_dwordx4 v[60:63], v4, s[16:19], s44 offen offset:1216 nt
    s_nop 7
    s_nop 3
    v_cvt_pk_bf16_f32 v239, v224, v225
    v_lshlrev_b32 v224, 16, v239
    v_and_b32 v225, 0xffff0000, v239
    v_mul_f32 v224, s30, v224
    v_mul_f32 v225, s30, v225
    v_cvt_pk_bf16_f32 v239, v224, v225
    v_lshlrev_b32 v224, 16, v239
    v_and_b32 v225, 0xffff0000, v239
    v_cvt_pk_bf16_f32 v239, v226, v227
    v_lshlrev_b32 v226, 16, v239
    v_and_b32 v227, 0xffff0000, v239
    v_mul_f32 v226, s30, v226
    v_mul_f32 v227, s30, v227
    v_cvt_pk_bf16_f32 v239, v226, v227
    v_lshlrev_b32 v226, 16, v239
    v_and_b32 v227, 0xffff0000, v239
    v_cvt_pk_bf16_f32 v239, v228, v229
    v_lshlrev_b32 v228, 16, v239
    v_and_b32 v229, 0xffff0000, v239
    v_mul_f32 v228, s30, v228
    v_mul_f32 v229, s30, v229
    v_cvt_pk_bf16_f32 v239, v228, v229
    v_lshlrev_b32 v228, 16, v239
    v_and_b32 v229, 0xffff0000, v239
    v_cvt_pk_bf16_f32 v239, v230, v231
    v_lshlrev_b32 v230, 16, v239
    v_and_b32 v231, 0xffff0000, v239
    v_mul_f32 v230, s30, v230
    v_mul_f32 v231, s30, v231
    v_cvt_pk_bf16_f32 v239, v230, v231
    v_lshlrev_b32 v230, 16, v239
    v_and_b32 v231, 0xffff0000, v239
    v_max3_f32 v239, v224, v225, v226
    v_max3_f32 v239, v239, v227, v228
    v_max3_f32 v239, v239, v229, v230
    v_max_f32 v239, v239, v231
    v_mov_b32 v240, v239
    s_nop 1
    v_permlane16_swap_b32 v239, v240
    s_nop 1
    v_max_f32 v239, v239, v240
    v_mov_b32 v240, v239
    s_nop 1
    v_permlane32_swap_b32 v239, v240
    s_nop 1
    v_max3_f32 v243, v239, v240, v236
    v_sub_f32 v238, v236, v243
    v_mul_f32 v238, s31, v238
    v_exp_f32 v238, v238
    v_mov_b32 v236, v243
    v_mul_f32 v241, s31, v243
    v_fma_f32 v224, v224, s31, -v241
    v_fma_f32 v225, v225, s31, -v241
    v_fma_f32 v226, v226, s31, -v241
    v_fma_f32 v227, v227, s31, -v241
    v_fma_f32 v228, v228, s31, -v241
    v_fma_f32 v229, v229, s31, -v241
    v_fma_f32 v230, v230, s31, -v241
    v_fma_f32 v231, v231, s31, -v241
    v_exp_f32 v224, v224
    v_exp_f32 v225, v225
    v_exp_f32 v226, v226
    v_exp_f32 v227, v227
    v_exp_f32 v228, v228
    v_exp_f32 v229, v229
    v_exp_f32 v230, v230
    v_exp_f32 v231, v231
    s_nop 0
    v_add_f32 v239, v224, v225
    v_add_f32 v240, v226, v227
    v_add_f32 v241, v228, v229
    v_add_f32 v242, v230, v231
    v_add_f32 v239, v239, v240
    v_add_f32 v241, v241, v242
    v_add_f32 v239, v239, v241
    v_fma_f32 v237, v237, v238, v239
    v_cvt_pk_bf16_f32 v232, v224, v225
    v_cvt_pk_bf16_f32 v233, v226, v227
    v_cvt_pk_bf16_f32 v234, v228, v229
    v_cvt_pk_bf16_f32 v235, v230, v231
    v_mul_f32 v192, v238, v192
    v_mul_f32 v193, v238, v193
    v_mul_f32 v194, v238, v194
    v_mul_f32 v195, v238, v195
    v_mul_f32 v196, v238, v196
    v_mul_f32 v197, v238, v197
    v_mul_f32 v198, v238, v198
    v_mul_f32 v199, v238, v199
    v_mul_f32 v200, v238, v200
    v_mul_f32 v201, v238, v201
    v_mul_f32 v202, v238, v202
    v_mul_f32 v203, v238, v203
    v_mul_f32 v204, v238, v204
    v_mul_f32 v205, v238, v205
    v_mul_f32 v206, v238, v206
    v_mul_f32 v207, v238, v207
    v_mul_f32 v208, v238, v208
    v_mul_f32 v209, v238, v209
    v_mul_f32 v210, v238, v210
    v_mul_f32 v211, v238, v211
    v_mul_f32 v212, v238, v212
    v_mul_f32 v213, v238, v213
    v_mul_f32 v214, v238, v214
    v_mul_f32 v215, v238, v215
    v_mul_f32 v216, v238, v216
    v_mul_f32 v217, v238, v217
    v_mul_f32 v218, v238, v218
    v_mul_f32 v219, v238, v219
    v_mul_f32 v220, v238, v220
    v_mul_f32 v221, v238, v221
    v_mul_f32 v222, v238, v222
    v_mul_f32 v223, v238, v223
    s_waitcnt vmcnt(24)
    v_perm_b32 v160, v100, v96, s28
    v_perm_b32 v164, v100, v96, s29
    v_perm_b32 v161, v108, v104, s28
    v_perm_b32 v165, v108, v104, s29
    v_perm_b32 v162, v116, v112, s28
    v_perm_b32 v166, v116, v112, s29
    v_perm_b32 v163, v124, v120, s28
    v_perm_b32 v167, v124, v120, s29
    v_perm_b32 v168, v101, v97, s28
    v_perm_b32 v172, v101, v97, s29
    v_perm_b32 v169, v109, v105, s28
    v_perm_b32 v173, v109, v105, s29
    v_perm_b32 v170, v117, v113, s28
    v_perm_b32 v174, v117, v113, s29
    v_perm_b32 v171, v125, v121, s28
    v_perm_b32 v175, v125, v121, s29
    v_perm_b32 v176, v102, v98, s28
    v_perm_b32 v180, v102, v98, s29
    v_perm_b32 v177, v110, v106, s28
    v_perm_b32 v181, v110, v106, s29
    v_perm_b32 v178, v118, v114, s28
    v_perm_b32 v182, v118, v114, s29
    v_perm_b32 v179, v126, v122, s28
    v_perm_b32 v183, v126, v122, s29
    v_perm_b32 v184, v103, v99, s28
    v_perm_b32 v188, v103, v99, s29
    v_perm_b32 v185, v111, v107, s28
    v_perm_b32 v189, v111, v107, s29
    v_perm_b32 v186, v119, v115, s28
    v_perm_b32 v190, v119, v115, s29
    v_perm_b32 v187, v127, v123, s28
    v_perm_b32 v191, v127, v123, s29
    s_nop 1
    v_mfma_f32_16x16x32_bf16 v[192:195], v[160:163], v[232:235], v[192:195]
    v_mfma_f32_16x16x32_bf16 v[196:199], v[164:167], v[232:235], v[196:199]
    v_mfma_f32_16x16x32_bf16 v[200:203], v[168:171], v[232:235], v[200:203]
    v_mfma_f32_16x16x32_bf16 v[204:207], v[172:175], v[232:235], v[204:207]
    v_mfma_f32_16x16x32_bf16 v[208:211], v[176:179], v[232:235], v[208:211]
    v_mfma_f32_16x16x32_bf16 v[212:215], v[180:183], v[232:235], v[212:215]
    v_mfma_f32_16x16x32_bf16 v[216:219], v[184:187], v[232:235], v[216:219]
    v_mfma_f32_16x16x32_bf16 v[220:223], v[188:191], v[232:235], v[220:223]
    buffer_load_dwordx4 v[96:99], v5, s[20:23], s44 offen offset:0 nt
    buffer_load_dwordx4 v[100:103], v5, s[20:23], s44 offen offset:256 nt
    buffer_load_dwordx4 v[104:107], v5, s[20:23], s44 offen offset:512 nt
    buffer_load_dwordx4 v[108:111], v5, s[20:23], s44 offen offset:768 nt
    buffer_load_dwordx4 v[112:115], v5, s[20:23], s44 offen offset:1024 nt
    buffer_load_dwordx4 v[116:119], v5, s[20:23], s44 offen offset:1280 nt
    buffer_load_dwordx4 v[120:123], v5, s[20:23], s44 offen offset:1536 nt
    buffer_load_dwordx4 v[124:127], v5, s[20:23], s44 offen offset:1792 nt
    s_nop 7
    s_nop 3
    s_waitcnt vmcnt(24)
    v_mfma_f32_16x16x32_bf16 v[224:227], v[64:67], v[16:19], 0
    v_mfma_f32_16x16x32_bf16 v[224:227], v[68:71], v[20:23], v[224:227]
    v_mfma_f32_16x16x32_bf16 v[224:227], v[72:75], v[24:27], v[224:227]
    v_mfma_f32_16x16x32_bf16 v[224:227], v[76:79], v[28:31], v[224:227]
    v_mfma_f32_16x16x32_bf16 v[228:231], v[80:83], v[16:19], 0
    v_mfma_f32_16x16x32_bf16 v[228:231], v[84:87], v[20:23], v[228:231]
    v_mfma_f32_16x16x32_bf16 v[228:231], v[88:91], v[24:27], v[228:231]
    v_mfma_f32_16x16x32_bf16 v[228:231], v[92:95], v[28:31], v[228:231]
    buffer_load_dwordx4 v[64:67], v4, s[16:19], s45 offen offset:0 nt
    buffer_load_dwordx4 v[68:71], v4, s[16:19], s45 offen offset:64 nt
    buffer_load_dwordx4 v[72:75], v4, s[16:19], s45 offen offset:128 nt
    buffer_load_dwordx4 v[76:79], v4, s[16:19], s45 offen offset:192 nt
    buffer_load_dwordx4 v[80:83], v4, s[16:19], s45 offen offset:1024 nt
    buffer_load_dwordx4 v[84:87], v4, s[16:19], s45 offen offset:1088 nt
    buffer_load_dwordx4 v[88:91], v4, s[16:19], s45 offen offset:1152 nt
    buffer_load_dwordx4 v[92:95], v4, s[16:19], s45 offen offset:1216 nt
    s_nop 7
    s_nop 3
    v_cvt_pk_bf16_f32 v239, v224, v225
    v_lshlrev_b32 v224, 16, v239
    v_and_b32 v225, 0xffff0000, v239
    v_mul_f32 v224, s30, v224
    v_mul_f32 v225, s30, v225
    v_cvt_pk_bf16_f32 v239, v224, v225
    v_lshlrev_b32 v224, 16, v239
    v_and_b32 v225, 0xffff0000, v239
    v_cvt_pk_bf16_f32 v239, v226, v227
    v_lshlrev_b32 v226, 16, v239
    v_and_b32 v227, 0xffff0000, v239
    v_mul_f32 v226, s30, v226
    v_mul_f32 v227, s30, v227
    v_cvt_pk_bf16_f32 v239, v226, v227
    v_lshlrev_b32 v226, 16, v239
    v_and_b32 v227, 0xffff0000, v239
    v_cvt_pk_bf16_f32 v239, v228, v229
    v_lshlrev_b32 v228, 16, v239
    v_and_b32 v229, 0xffff0000, v239
    v_mul_f32 v228, s30, v228
    v_mul_f32 v229, s30, v229
    v_cvt_pk_bf16_f32 v239, v228, v229
    v_lshlrev_b32 v228, 16, v239
    v_and_b32 v229, 0xffff0000, v239
    v_cvt_pk_bf16_f32 v239, v230, v231
    v_lshlrev_b32 v230, 16, v239
    v_and_b32 v231, 0xffff0000, v239
    v_mul_f32 v230, s30, v230
    v_mul_f32 v231, s30, v231
    v_cvt_pk_bf16_f32 v239, v230, v231
    v_lshlrev_b32 v230, 16, v239
    v_and_b32 v231, 0xffff0000, v239
    v_max3_f32 v239, v224, v225, v226
    v_max3_f32 v239, v239, v227, v228
    v_max3_f32 v239, v239, v229, v230
    v_max_f32 v239, v239, v231
    v_mov_b32 v240, v239
    s_nop 1
    v_permlane16_swap_b32 v239, v240
    s_nop 1
    v_max_f32 v239, v239, v240
    v_mov_b32 v240, v239
    s_nop 1
    v_permlane32_swap_b32 v239, v240
    s_nop 1
    v_max3_f32 v243, v239, v240, v236
    v_sub_f32 v238, v236, v243
    v_mul_f32 v238, s31, v238
    v_exp_f32 v238, v238
    v_mov_b32 v236, v243
    v_mul_f32 v241, s31, v243
    v_fma_f32 v224, v224, s31, -v241
    v_fma_f32 v225, v225, s31, -v241
    v_fma_f32 v226, v226, s31, -v241
    v_fma_f32 v227, v227, s31, -v241
    v_fma_f32 v228, v228, s31, -v241
    v_fma_f32 v229, v229, s31, -v241
    v_fma_f32 v230, v230, s31, -v241
    v_fma_f32 v231, v231, s31, -v241
    v_exp_f32 v224, v224
    v_exp_f32 v225, v225
    v_exp_f32 v226, v226
    v_exp_f32 v227, v227
    v_exp_f32 v228, v228
    v_exp_f32 v229, v229
    v_exp_f32 v230, v230
    v_exp_f32 v231, v231
    s_nop 0
    v_add_f32 v239, v224, v225
    v_add_f32 v240, v226, v227
    v_add_f32 v241, v228, v229
    v_add_f32 v242, v230, v231
    v_add_f32 v239, v239, v240
    v_add_f32 v241, v241, v242
    v_add_f32 v239, v239, v241
    v_fma_f32 v237, v237, v238, v239
    v_cvt_pk_bf16_f32 v232, v224, v225
    v_cvt_pk_bf16_f32 v233, v226, v227
    v_cvt_pk_bf16_f32 v234, v228, v229
    v_cvt_pk_bf16_f32 v235, v230, v231
    v_mul_f32 v192, v238, v192
    v_mul_f32 v193, v238, v193
    v_mul_f32 v194, v238, v194
    v_mul_f32 v195, v238, v195
    v_mul_f32 v196, v238, v196
    v_mul_f32 v197, v238, v197
    v_mul_f32 v198, v238, v198
    v_mul_f32 v199, v238, v199
    v_mul_f32 v200, v238, v200
    v_mul_f32 v201, v238, v201
    v_mul_f32 v202, v238, v202
    v_mul_f32 v203, v238, v203
    v_mul_f32 v204, v238, v204
    v_mul_f32 v205, v238, v205
    v_mul_f32 v206, v238, v206
    v_mul_f32 v207, v238, v207
    v_mul_f32 v208, v238, v208
    v_mul_f32 v209, v238, v209
    v_mul_f32 v210, v238, v210
    v_mul_f32 v211, v238, v211
    v_mul_f32 v212, v238, v212
    v_mul_f32 v213, v238, v213
    v_mul_f32 v214, v238, v214
    v_mul_f32 v215, v238, v215
    v_mul_f32 v216, v238, v216
    v_mul_f32 v217, v238, v217
    v_mul_f32 v218, v238, v218
    v_mul_f32 v219, v238, v219
    v_mul_f32 v220, v238, v220
    v_mul_f32 v221, v238, v221
    v_mul_f32 v222, v238, v222
    v_mul_f32 v223, v238, v223
    s_waitcnt vmcnt(24)
    v_perm_b32 v160, v132, v128, s28
    v_perm_b32 v164, v132, v128, s29
    v_perm_b32 v161, v140, v136, s28
    v_perm_b32 v165, v140, v136, s29
    v_perm_b32 v162, v148, v144, s28
    v_perm_b32 v166, v148, v144, s29
    v_perm_b32 v163, v156, v152, s28
    v_perm_b32 v167, v156, v152, s29
    v_perm_b32 v168, v133, v129, s28
    v_perm_b32 v172, v133, v129, s29
    v_perm_b32 v169, v141, v137, s28
    v_perm_b32 v173, v141, v137, s29
    v_perm_b32 v170, v149, v145, s28
    v_perm_b32 v174, v149, v145, s29
    v_perm_b32 v171, v157, v153, s28
    v_perm_b32 v175, v157, v153, s29
    v_perm_b32 v176, v134, v130, s28
    v_perm_b32 v180, v134, v130, s29
    v_perm_b32 v177, v142, v138, s28
    v_perm_b32 v181, v142, v138, s29
    v_perm_b32 v178, v150, v146, s28
    v_perm_b32 v182, v150, v146, s29
    v_perm_b32 v179, v158, v154, s28
    v_perm_b32 v183, v158, v154, s29
    v_perm_b32 v184, v135, v131, s28
    v_perm_b32 v188, v135, v131, s29
    v_perm_b32 v185, v143, v139, s28
    v_perm_b32 v189, v143, v139, s29
    v_perm_b32 v186, v151, v147, s28
    v_perm_b32 v190, v151, v147, s29
    v_perm_b32 v187, v159, v155, s28
    v_perm_b32 v191, v159, v155, s29
    s_nop 1
    v_mfma_f32_16x16x32_bf16 v[192:195], v[160:163], v[232:235], v[192:195]
    v_mfma_f32_16x16x32_bf16 v[196:199], v[164:167], v[232:235], v[196:199]
    v_mfma_f32_16x16x32_bf16 v[200:203], v[168:171], v[232:235], v[200:203]
    v_mfma_f32_16x16x32_bf16 v[204:207], v[172:175], v[232:235], v[204:207]
    v_mfma_f32_16x16x32_bf16 v[208:211], v[176:179], v[232:235], v[208:211]
    v_mfma_f32_16x16x32_bf16 v[212:215], v[180:183], v[232:235], v[212:215]
    v_mfma_f32_16x16x32_bf16 v[216:219], v[184:187], v[232:235], v[216:219]
    v_mfma_f32_16x16x32_bf16 v[220:223], v[188:191], v[232:235], v[220:223]
    buffer_load_dwordx4 v[128:131], v5, s[20:23], s45 offen offset:0 nt
    buffer_load_dwordx4 v[132:135], v5, s[20:23], s45 offen offset:256 nt
    buffer_load_dwordx4 v[136:139], v5, s[20:23], s45 offen offset:512 nt
    buffer_load_dwordx4 v[140:143], v5, s[20:23], s45 offen offset:768 nt
    buffer_load_dwordx4 v[144:147], v5, s[20:23], s45 offen offset:1024 nt
    buffer_load_dwordx4 v[148:151], v5, s[20:23], s45 offen offset:1280 nt
    buffer_load_dwordx4 v[152:155], v5, s[20:23], s45 offen offset:1536 nt
    buffer_load_dwordx4 v[156:159], v5, s[20:23], s45 offen offset:1792 nt
    s_nop 7
    s_nop 3
    s_waitcnt vmcnt(24)
    v_mfma_f32_16x16x32_bf16 v[224:227], v[32:35], v[16:19], 0
    v_mfma_f32_16x16x32_bf16 v[224:227], v[36:39], v[20:23], v[224:227]
    v_mfma_f32_16x16x32_bf16 v[224:227], v[40:43], v[24:27], v[224:227]
    v_mfma_f32_16x16x32_bf16 v[224:227], v[44:47], v[28:31], v[224:227]
    v_mfma_f32_16x16x32_bf16 v[228:231], v[48:51], v[16:19], 0
    v_mfma_f32_16x16x32_bf16 v[228:231], v[52:55], v[20:23], v[228:231]
    v_mfma_f32_16x16x32_bf16 v[228:231], v[56:59], v[24:27], v[228:231]
    v_mfma_f32_16x16x32_bf16 v[228:231], v[60:63], v[28:31], v[228:231]
    buffer_load_dwordx4 v[32:35], v4, s[16:19], s46 offen offset:0 nt
    buffer_load_dwordx4 v[36:39], v4, s[16:19], s46 offen offset:64 nt
    buffer_load_dwordx4 v[40:43], v4, s[16:19], s46 offen offset:128 nt
    buffer_load_dwordx4 v[44:47], v4, s[16:19], s46 offen offset:192 nt
    buffer_load_dwordx4 v[48:51], v4, s[16:19], s46 offen offset:1024 nt
    buffer_load_dwordx4 v[52:55], v4, s[16:19], s46 offen offset:1088 nt
    buffer_load_dwordx4 v[56:59], v4, s[16:19], s46 offen offset:1152 nt
    buffer_load_dwordx4 v[60:63], v4, s[16:19], s46 offen offset:1216 nt
    s_nop 7
    s_nop 3
    v_cvt_pk_bf16_f32 v239, v224, v225
    v_lshlrev_b32 v224, 16, v239
    v_and_b32 v225, 0xffff0000, v239
    v_mul_f32 v224, s30, v224
    v_mul_f32 v225, s30, v225
    v_cvt_pk_bf16_f32 v239, v224, v225
    v_lshlrev_b32 v224, 16, v239
    v_and_b32 v225, 0xffff0000, v239
    v_cvt_pk_bf16_f32 v239, v226, v227
    v_lshlrev_b32 v226, 16, v239
    v_and_b32 v227, 0xffff0000, v239
    v_mul_f32 v226, s30, v226
    v_mul_f32 v227, s30, v227
    v_cvt_pk_bf16_f32 v239, v226, v227
    v_lshlrev_b32 v226, 16, v239
    v_and_b32 v227, 0xffff0000, v239
    v_cvt_pk_bf16_f32 v239, v228, v229
    v_lshlrev_b32 v228, 16, v239
    v_and_b32 v229, 0xffff0000, v239
    v_mul_f32 v228, s30, v228
    v_mul_f32 v229, s30, v229
    v_cvt_pk_bf16_f32 v239, v228, v229
    v_lshlrev_b32 v228, 16, v239
    v_and_b32 v229, 0xffff0000, v239
    v_cvt_pk_bf16_f32 v239, v230, v231
    v_lshlrev_b32 v230, 16, v239
    v_and_b32 v231, 0xffff0000, v239
    v_mul_f32 v230, s30, v230
    v_mul_f32 v231, s30, v231
    v_cvt_pk_bf16_f32 v239, v230, v231
    v_lshlrev_b32 v230, 16, v239
    v_and_b32 v231, 0xffff0000, v239
    v_max3_f32 v239, v224, v225, v226
    v_max3_f32 v239, v239, v227, v228
    v_max3_f32 v239, v239, v229, v230
    v_max_f32 v239, v239, v231
    v_mov_b32 v240, v239
    s_nop 1
    v_permlane16_swap_b32 v239, v240
    s_nop 1
    v_max_f32 v239, v239, v240
    v_mov_b32 v240, v239
    s_nop 1
    v_permlane32_swap_b32 v239, v240
    s_nop 1
    v_max3_f32 v243, v239, v240, v236
    v_sub_f32 v238, v236, v243
    v_mul_f32 v238, s31, v238
    v_exp_f32 v238, v238
    v_mov_b32 v236, v243
    v_mul_f32 v241, s31, v243
    v_fma_f32 v224, v224, s31, -v241
    v_fma_f32 v225, v225, s31, -v241
    v_fma_f32 v226, v226, s31, -v241
    v_fma_f32 v227, v227, s31, -v241
    v_fma_f32 v228, v228, s31, -v241
    v_fma_f32 v229, v229, s31, -v241
    v_fma_f32 v230, v230, s31, -v241
    v_fma_f32 v231, v231, s31, -v241
    v_exp_f32 v224, v224
    v_exp_f32 v225, v225
    v_exp_f32 v226, v226
    v_exp_f32 v227, v227
    v_exp_f32 v228, v228
    v_exp_f32 v229, v229
    v_exp_f32 v230, v230
    v_exp_f32 v231, v231
    s_nop 0
    v_add_f32 v239, v224, v225
    v_add_f32 v240, v226, v227
    v_add_f32 v241, v228, v229
    v_add_f32 v242, v230, v231
    v_add_f32 v239, v239, v240
    v_add_f32 v241, v241, v242
    v_add_f32 v239, v239, v241
    v_fma_f32 v237, v237, v238, v239
    v_cvt_pk_bf16_f32 v232, v224, v225
    v_cvt_pk_bf16_f32 v233, v226, v227
    v_cvt_pk_bf16_f32 v234, v228, v229
    v_cvt_pk_bf16_f32 v235, v230, v231
    v_mul_f32 v192, v238, v192
    v_mul_f32 v193, v238, v193
    v_mul_f32 v194, v238, v194
    v_mul_f32 v195, v238, v195
    v_mul_f32 v196, v238, v196
    v_mul_f32 v197, v238, v197
    v_mul_f32 v198, v238, v198
    v_mul_f32 v199, v238, v199
    v_mul_f32 v200, v238, v200
    v_mul_f32 v201, v238, v201
    v_mul_f32 v202, v238, v202
    v_mul_f32 v203, v238, v203
    v_mul_f32 v204, v238, v204
    v_mul_f32 v205, v238, v205
    v_mul_f32 v206, v238, v206
    v_mul_f32 v207, v238, v207
    v_mul_f32 v208, v238, v208
    v_mul_f32 v209, v238, v209
    v_mul_f32 v210, v238, v210
    v_mul_f32 v211, v238, v211
    v_mul_f32 v212, v238, v212
    v_mul_f32 v213, v238, v213
    v_mul_f32 v214, v238, v214
    v_mul_f32 v215, v238, v215
    v_mul_f32 v216, v238, v216
    v_mul_f32 v217, v238, v217
    v_mul_f32 v218, v238, v218
    v_mul_f32 v219, v238, v219
    v_mul_f32 v220, v238, v220
    v_mul_f32 v221, v238, v221
    v_mul_f32 v222, v238, v222
    v_mul_f32 v223, v238, v223
    s_waitcnt vmcnt(24)
    v_perm_b32 v160, v100, v96, s28
    v_perm_b32 v164, v100, v96, s29
    v_perm_b32 v161, v108, v104, s28
    v_perm_b32 v165, v108, v104, s29
    v_perm_b32 v162, v116, v112, s28
    v_perm_b32 v166, v116, v112, s29
    v_perm_b32 v163, v124, v120, s28
    v_perm_b32 v167, v124, v120, s29
    v_perm_b32 v168, v101, v97, s28
    v_perm_b32 v172, v101, v97, s29
    v_perm_b32 v169, v109, v105, s28
    v_perm_b32 v173, v109, v105, s29
    v_perm_b32 v170, v117, v113, s28
    v_perm_b32 v174, v117, v113, s29
    v_perm_b32 v171, v125, v121, s28
    v_perm_b32 v175, v125, v121, s29
    v_perm_b32 v176, v102, v98, s28
    v_perm_b32 v180, v102, v98, s29
    v_perm_b32 v177, v110, v106, s28
    v_perm_b32 v181, v110, v106, s29
    v_perm_b32 v178, v118, v114, s28
    v_perm_b32 v182, v118, v114, s29
    v_perm_b32 v179, v126, v122, s28
    v_perm_b32 v183, v126, v122, s29
    v_perm_b32 v184, v103, v99, s28
    v_perm_b32 v188, v103, v99, s29
    v_perm_b32 v185, v111, v107, s28
    v_perm_b32 v189, v111, v107, s29
    v_perm_b32 v186, v119, v115, s28
    v_perm_b32 v190, v119, v115, s29
    v_perm_b32 v187, v127, v123, s28
    v_perm_b32 v191, v127, v123, s29
    s_nop 1
    v_mfma_f32_16x16x32_bf16 v[192:195], v[160:163], v[232:235], v[192:195]
    v_mfma_f32_16x16x32_bf16 v[196:199], v[164:167], v[232:235], v[196:199]
    v_mfma_f32_16x16x32_bf16 v[200:203], v[168:171], v[232:235], v[200:203]
    v_mfma_f32_16x16x32_bf16 v[204:207], v[172:175], v[232:235], v[204:207]
    v_mfma_f32_16x16x32_bf16 v[208:211], v[176:179], v[232:235], v[208:211]
    v_mfma_f32_16x16x32_bf16 v[212:215], v[180:183], v[232:235], v[212:215]
    v_mfma_f32_16x16x32_bf16 v[216:219], v[184:187], v[232:235], v[216:219]
    v_mfma_f32_16x16x32_bf16 v[220:223], v[188:191], v[232:235], v[220:223]
    buffer_load_dwordx4 v[96:99], v5, s[20:23], s46 offen offset:0 nt
    buffer_load_dwordx4 v[100:103], v5, s[20:23], s46 offen offset:256 nt
    buffer_load_dwordx4 v[104:107], v5, s[20:23], s46 offen offset:512 nt
    buffer_load_dwordx4 v[108:111], v5, s[20:23], s46 offen offset:768 nt
    buffer_load_dwordx4 v[112:115], v5, s[20:23], s46 offen offset:1024 nt
    buffer_load_dwordx4 v[116:119], v5, s[20:23], s46 offen offset:1280 nt
    buffer_load_dwordx4 v[120:123], v5, s[20:23], s46 offen offset:1536 nt
    buffer_load_dwordx4 v[124:127], v5, s[20:23], s46 offen offset:1792 nt
    s_nop 7
    s_nop 3
    s_waitcnt vmcnt(24)
    v_mfma_f32_16x16x32_bf16 v[224:227], v[64:67], v[16:19], 0
    v_mfma_f32_16x16x32_bf16 v[224:227], v[68:71], v[20:23], v[224:227]
    v_mfma_f32_16x16x32_bf16 v[224:227], v[72:75], v[24:27], v[224:227]
    v_mfma_f32_16x16x32_bf16 v[224:227], v[76:79], v[28:31], v[224:227]
    v_mfma_f32_16x16x32_bf16 v[228:231], v[80:83], v[16:19], 0
    v_mfma_f32_16x16x32_bf16 v[228:231], v[84:87], v[20:23], v[228:231]
    v_mfma_f32_16x16x32_bf16 v[228:231], v[88:91], v[24:27], v[228:231]
    v_mfma_f32_16x16x32_bf16 v[228:231], v[92:95], v[28:31], v[228:231]
    buffer_load_dwordx4 v[64:67], v4, s[16:19], s47 offen offset:0 nt
    buffer_load_dwordx4 v[68:71], v4, s[16:19], s47 offen offset:64 nt
    buffer_load_dwordx4 v[72:75], v4, s[16:19], s47 offen offset:128 nt
    buffer_load_dwordx4 v[76:79], v4, s[16:19], s47 offen offset:192 nt
    buffer_load_dwordx4 v[80:83], v4, s[16:19], s47 offen offset:1024 nt
    buffer_load_dwordx4 v[84:87], v4, s[16:19], s47 offen offset:1088 nt
    buffer_load_dwordx4 v[88:91], v4, s[16:19], s47 offen offset:1152 nt
    buffer_load_dwordx4 v[92:95], v4, s[16:19], s47 offen offset:1216 nt
    s_nop 7
    s_nop 3
    v_cvt_pk_bf16_f32 v239, v224, v225
    v_lshlrev_b32 v224, 16, v239
    v_and_b32 v225, 0xffff0000, v239
    v_mul_f32 v224, s30, v224
    v_mul_f32 v225, s30, v225
    v_cvt_pk_bf16_f32 v239, v224, v225
    v_lshlrev_b32 v224, 16, v239
    v_and_b32 v225, 0xffff0000, v239
    v_cvt_pk_bf16_f32 v239, v226, v227
    v_lshlrev_b32 v226, 16, v239
    v_and_b32 v227, 0xffff0000, v239
    v_mul_f32 v226, s30, v226
    v_mul_f32 v227, s30, v227
    v_cvt_pk_bf16_f32 v239, v226, v227
    v_lshlrev_b32 v226, 16, v239
    v_and_b32 v227, 0xffff0000, v239
    v_cvt_pk_bf16_f32 v239, v228, v229
    v_lshlrev_b32 v228, 16, v239
    v_and_b32 v229, 0xffff0000, v239
    v_mul_f32 v228, s30, v228
    v_mul_f32 v229, s30, v229
    v_cvt_pk_bf16_f32 v239, v228, v229
    v_lshlrev_b32 v228, 16, v239
    v_and_b32 v229, 0xffff0000, v239
    v_cvt_pk_bf16_f32 v239, v230, v231
    v_lshlrev_b32 v230, 16, v239
    v_and_b32 v231, 0xffff0000, v239
    v_mul_f32 v230, s30, v230
    v_mul_f32 v231, s30, v231
    v_cvt_pk_bf16_f32 v239, v230, v231
    v_lshlrev_b32 v230, 16, v239
    v_and_b32 v231, 0xffff0000, v239
    v_max3_f32 v239, v224, v225, v226
    v_max3_f32 v239, v239, v227, v228
    v_max3_f32 v239, v239, v229, v230
    v_max_f32 v239, v239, v231
    v_mov_b32 v240, v239
    s_nop 1
    v_permlane16_swap_b32 v239, v240
    s_nop 1
    v_max_f32 v239, v239, v240
    v_mov_b32 v240, v239
    s_nop 1
    v_permlane32_swap_b32 v239, v240
    s_nop 1
    v_max3_f32 v243, v239, v240, v236
    v_sub_f32 v238, v236, v243
    v_mul_f32 v238, s31, v238
    v_exp_f32 v238, v238
    v_mov_b32 v236, v243
    v_mul_f32 v241, s31, v243
    v_fma_f32 v224, v224, s31, -v241
    v_fma_f32 v225, v225, s31, -v241
    v_fma_f32 v226, v226, s31, -v241
    v_fma_f32 v227, v227, s31, -v241
    v_fma_f32 v228, v228, s31, -v241
    v_fma_f32 v229, v229, s31, -v241
    v_fma_f32 v230, v230, s31, -v241
    v_fma_f32 v231, v231, s31, -v241
    v_exp_f32 v224, v224
    v_exp_f32 v225, v225
    v_exp_f32 v226, v226
    v_exp_f32 v227, v227
    v_exp_f32 v228, v228
    v_exp_f32 v229, v229
    v_exp_f32 v230, v230
    v_exp_f32 v231, v231
    s_nop 0
    v_add_f32 v239, v224, v225
    v_add_f32 v240, v226, v227
    v_add_f32 v241, v228, v229
    v_add_f32 v242, v230, v231
    v_add_f32 v239, v239, v240
    v_add_f32 v241, v241, v242
    v_add_f32 v239, v239, v241
    v_fma_f32 v237, v237, v238, v239
    v_cvt_pk_bf16_f32 v232, v224, v225
    v_cvt_pk_bf16_f32 v233, v226, v227
    v_cvt_pk_bf16_f32 v234, v228, v229
    v_cvt_pk_bf16_f32 v235, v230, v231
    v_mul_f32 v192, v238, v192
    v_mul_f32 v193, v238, v193
    v_mul_f32 v194, v238, v194
    v_mul_f32 v195, v238, v195
    v_mul_f32 v196, v238, v196
    v_mul_f32 v197, v238, v197
    v_mul_f32 v198, v238, v198
    v_mul_f32 v199, v238, v199
    v_mul_f32 v200, v238, v200
    v_mul_f32 v201, v238, v201
    v_mul_f32 v202, v238, v202
    v_mul_f32 v203, v238, v203
    v_mul_f32 v204, v238, v204
    v_mul_f32 v205, v238, v205
    v_mul_f32 v206, v238, v206
    v_mul_f32 v207, v238, v207
    v_mul_f32 v208, v238, v208
    v_mul_f32 v209, v238, v209
    v_mul_f32 v210, v238, v210
    v_mul_f32 v211, v238, v211
    v_mul_f32 v212, v238, v212
    v_mul_f32 v213, v238, v213
    v_mul_f32 v214, v238, v214
    v_mul_f32 v215, v238, v215
    v_mul_f32 v216, v238, v216
    v_mul_f32 v217, v238, v217
    v_mul_f32 v218, v238, v218
    v_mul_f32 v219, v238, v219
    v_mul_f32 v220, v238, v220
    v_mul_f32 v221, v238, v221
    v_mul_f32 v222, v238, v222
    v_mul_f32 v223, v238, v223
    s_waitcnt vmcnt(24)
    v_perm_b32 v160, v132, v128, s28
    v_perm_b32 v164, v132, v128, s29
    v_perm_b32 v161, v140, v136, s28
    v_perm_b32 v165, v140, v136, s29
    v_perm_b32 v162, v148, v144, s28
    v_perm_b32 v166, v148, v144, s29
    v_perm_b32 v163, v156, v152, s28
    v_perm_b32 v167, v156, v152, s29
    v_perm_b32 v168, v133, v129, s28
    v_perm_b32 v172, v133, v129, s29
    v_perm_b32 v169, v141, v137, s28
    v_perm_b32 v173, v141, v137, s29
    v_perm_b32 v170, v149, v145, s28
    v_perm_b32 v174, v149, v145, s29
    v_perm_b32 v171, v157, v153, s28
    v_perm_b32 v175, v157, v153, s29
    v_perm_b32 v176, v134, v130, s28
    v_perm_b32 v180, v134, v130, s29
    v_perm_b32 v177, v142, v138, s28
    v_perm_b32 v181, v142, v138, s29
    v_perm_b32 v178, v150, v146, s28
    v_perm_b32 v182, v150, v146, s29
    v_perm_b32 v179, v158, v154, s28
    v_perm_b32 v183, v158, v154, s29
    v_perm_b32 v184, v135, v131, s28
    v_perm_b32 v188, v135, v131, s29
    v_perm_b32 v185, v143, v139, s28
    v_perm_b32 v189, v143, v139, s29
    v_perm_b32 v186, v151, v147, s28
    v_perm_b32 v190, v151, v147, s29
    v_perm_b32 v187, v159, v155, s28
    v_perm_b32 v191, v159, v155, s29
    s_nop 1
    v_mfma_f32_16x16x32_bf16 v[192:195], v[160:163], v[232:235], v[192:195]
    v_mfma_f32_16x16x32_bf16 v[196:199], v[164:167], v[232:235], v[196:199]
    v_mfma_f32_16x16x32_bf16 v[200:203], v[168:171], v[232:235], v[200:203]
    v_mfma_f32_16x16x32_bf16 v[204:207], v[172:175], v[232:235], v[204:207]
    v_mfma_f32_16x16x32_bf16 v[208:211], v[176:179], v[232:235], v[208:211]
    v_mfma_f32_16x16x32_bf16 v[212:215], v[180:183], v[232:235], v[212:215]
    v_mfma_f32_16x16x32_bf16 v[216:219], v[184:187], v[232:235], v[216:219]
    v_mfma_f32_16x16x32_bf16 v[220:223], v[188:191], v[232:235], v[220:223]
    buffer_load_dwordx4 v[128:131], v5, s[20:23], s47 offen offset:0 nt
    buffer_load_dwordx4 v[132:135], v5, s[20:23], s47 offen offset:256 nt
    buffer_load_dwordx4 v[136:139], v5, s[20:23], s47 offen offset:512 nt
    buffer_load_dwordx4 v[140:143], v5, s[20:23], s47 offen offset:768 nt
    buffer_load_dwordx4 v[144:147], v5, s[20:23], s47 offen offset:1024 nt
    buffer_load_dwordx4 v[148:151], v5, s[20:23], s47 offen offset:1280 nt
    buffer_load_dwordx4 v[152:155], v5, s[20:23], s47 offen offset:1536 nt
    buffer_load_dwordx4 v[156:159], v5, s[20:23], s47 offen offset:1792 nt
    s_nop 7
    s_nop 3
    s_waitcnt vmcnt(24)
    v_mfma_f32_16x16x32_bf16 v[224:227], v[32:35], v[16:19], 0
    v_mfma_f32_16x16x32_bf16 v[224:227], v[36:39], v[20:23], v[224:227]
    v_mfma_f32_16x16x32_bf16 v[224:227], v[40:43], v[24:27], v[224:227]
    v_mfma_f32_16x16x32_bf16 v[224:227], v[44:47], v[28:31], v[224:227]
    v_mfma_f32_16x16x32_bf16 v[228:231], v[48:51], v[16:19], 0
    v_mfma_f32_16x16x32_bf16 v[228:231], v[52:55], v[20:23], v[228:231]
    v_mfma_f32_16x16x32_bf16 v[228:231], v[56:59], v[24:27], v[228:231]
    v_mfma_f32_16x16x32_bf16 v[228:231], v[60:63], v[28:31], v[228:231]
    s_nop 7
    s_nop 3
    v_cvt_pk_bf16_f32 v239, v224, v225
    v_lshlrev_b32 v224, 16, v239
    v_and_b32 v225, 0xffff0000, v239
    v_mul_f32 v224, s30, v224
    v_mul_f32 v225, s30, v225
    v_cvt_pk_bf16_f32 v239, v224, v225
    v_lshlrev_b32 v224, 16, v239
    v_and_b32 v225, 0xffff0000, v239
    v_cvt_pk_bf16_f32 v239, v226, v227
    v_lshlrev_b32 v226, 16, v239
    v_and_b32 v227, 0xffff0000, v239
    v_mul_f32 v226, s30, v226
    v_mul_f32 v227, s30, v227
    v_cvt_pk_bf16_f32 v239, v226, v227
    v_lshlrev_b32 v226, 16, v239
    v_and_b32 v227, 0xffff0000, v239
    v_cvt_pk_bf16_f32 v239, v228, v229
    v_lshlrev_b32 v228, 16, v239
    v_and_b32 v229, 0xffff0000, v239
    v_mul_f32 v228, s30, v228
    v_mul_f32 v229, s30, v229
    v_cvt_pk_bf16_f32 v239, v228, v229
    v_lshlrev_b32 v228, 16, v239
    v_and_b32 v229, 0xffff0000, v239
    v_cvt_pk_bf16_f32 v239, v230, v231
    v_lshlrev_b32 v230, 16, v239
    v_and_b32 v231, 0xffff0000, v239
    v_mul_f32 v230, s30, v230
    v_mul_f32 v231, s30, v231
    v_cvt_pk_bf16_f32 v239, v230, v231
    v_lshlrev_b32 v230, 16, v239
    v_and_b32 v231, 0xffff0000, v239
    v_max3_f32 v239, v224, v225, v226
    v_max3_f32 v239, v239, v227, v228
    v_max3_f32 v239, v239, v229, v230
    v_max_f32 v239, v239, v231
    v_mov_b32 v240, v239
    s_nop 1
    v_permlane16_swap_b32 v239, v240
    s_nop 1
    v_max_f32 v239, v239, v240
    v_mov_b32 v240, v239
    s_nop 1
    v_permlane32_swap_b32 v239, v240
    s_nop 1
    v_max3_f32 v243, v239, v240, v236
    v_sub_f32 v238, v236, v243
    v_mul_f32 v238, s31, v238
    v_exp_f32 v238, v238
    v_mov_b32 v236, v243
    v_mul_f32 v241, s31, v243
    v_fma_f32 v224, v224, s31, -v241
    v_fma_f32 v225, v225, s31, -v241
    v_fma_f32 v226, v226, s31, -v241
    v_fma_f32 v227, v227, s31, -v241
    v_fma_f32 v228, v228, s31, -v241
    v_fma_f32 v229, v229, s31, -v241
    v_fma_f32 v230, v230, s31, -v241
    v_fma_f32 v231, v231, s31, -v241
    v_exp_f32 v224, v224
    v_exp_f32 v225, v225
    v_exp_f32 v226, v226
    v_exp_f32 v227, v227
    v_exp_f32 v228, v228
    v_exp_f32 v229, v229
    v_exp_f32 v230, v230
    v_exp_f32 v231, v231
    s_nop 0
    v_add_f32 v239, v224, v225
    v_add_f32 v240, v226, v227
    v_add_f32 v241, v228, v229
    v_add_f32 v242, v230, v231
    v_add_f32 v239, v239, v240
    v_add_f32 v241, v241, v242
    v_add_f32 v239, v239, v241
    v_fma_f32 v237, v237, v238, v239
    v_cvt_pk_bf16_f32 v232, v224, v225
    v_cvt_pk_bf16_f32 v233, v226, v227
    v_cvt_pk_bf16_f32 v234, v228, v229
    v_cvt_pk_bf16_f32 v235, v230, v231
    v_mul_f32 v192, v238, v192
    v_mul_f32 v193, v238, v193
    v_mul_f32 v194, v238, v194
    v_mul_f32 v195, v238, v195
    v_mul_f32 v196, v238, v196
    v_mul_f32 v197, v238, v197
    v_mul_f32 v198, v238, v198
    v_mul_f32 v199, v238, v199
    v_mul_f32 v200, v238, v200
    v_mul_f32 v201, v238, v201
    v_mul_f32 v202, v238, v202
    v_mul_f32 v203, v238, v203
    v_mul_f32 v204, v238, v204
    v_mul_f32 v205, v238, v205
    v_mul_f32 v206, v238, v206
    v_mul_f32 v207, v238, v207
    v_mul_f32 v208, v238, v208
    v_mul_f32 v209, v238, v209
    v_mul_f32 v210, v238, v210
    v_mul_f32 v211, v238, v211
    v_mul_f32 v212, v238, v212
    v_mul_f32 v213, v238, v213
    v_mul_f32 v214, v238, v214
    v_mul_f32 v215, v238, v215
    v_mul_f32 v216, v238, v216
    v_mul_f32 v217, v238, v217
    v_mul_f32 v218, v238, v218
    v_mul_f32 v219, v238, v219
    v_mul_f32 v220, v238, v220
    v_mul_f32 v221, v238, v221
    v_mul_f32 v222, v238, v222
    v_mul_f32 v223, v238, v223
    s_waitcnt vmcnt(16)
    v_perm_b32 v160, v100, v96, s28
    v_perm_b32 v164, v100, v96, s29
    v_perm_b32 v161, v108, v104, s28
    v_perm_b32 v165, v108, v104, s29
    v_perm_b32 v162, v116, v112, s28
    v_perm_b32 v166, v116, v112, s29
    v_perm_b32 v163, v124, v120, s28
    v_perm_b32 v167, v124, v120, s29
    v_perm_b32 v168, v101, v97, s28
    v_perm_b32 v172, v101, v97, s29
    v_perm_b32 v169, v109, v105, s28
    v_perm_b32 v173, v109, v105, s29
    v_perm_b32 v170, v117, v113, s28
    v_perm_b32 v174, v117, v113, s29
    v_perm_b32 v171, v125, v121, s28
    v_perm_b32 v175, v125, v121, s29
    v_perm_b32 v176, v102, v98, s28
    v_perm_b32 v180, v102, v98, s29
    v_perm_b32 v177, v110, v106, s28
    v_perm_b32 v181, v110, v106, s29
    v_perm_b32 v178, v118, v114, s28
    v_perm_b32 v182, v118, v114, s29
    v_perm_b32 v179, v126, v122, s28
    v_perm_b32 v183, v126, v122, s29
    v_perm_b32 v184, v103, v99, s28
    v_perm_b32 v188, v103, v99, s29
    v_perm_b32 v185, v111, v107, s28
    v_perm_b32 v189, v111, v107, s29
    v_perm_b32 v186, v119, v115, s28
    v_perm_b32 v190, v119, v115, s29
    v_perm_b32 v187, v127, v123, s28
    v_perm_b32 v191, v127, v123, s29
    s_nop 1
    v_mfma_f32_16x16x32_bf16 v[192:195], v[160:163], v[232:235], v[192:195]
    v_mfma_f32_16x16x32_bf16 v[196:199], v[164:167], v[232:235], v[196:199]
    v_mfma_f32_16x16x32_bf16 v[200:203], v[168:171], v[232:235], v[200:203]
    v_mfma_f32_16x16x32_bf16 v[204:207], v[172:175], v[232:235], v[204:207]
    v_mfma_f32_16x16x32_bf16 v[208:211], v[176:179], v[232:235], v[208:211]
    v_mfma_f32_16x16x32_bf16 v[212:215], v[180:183], v[232:235], v[212:215]
    v_mfma_f32_16x16x32_bf16 v[216:219], v[184:187], v[232:235], v[216:219]
    v_mfma_f32_16x16x32_bf16 v[220:223], v[188:191], v[232:235], v[220:223]
    s_nop 7
    s_nop 3
    s_waitcnt vmcnt(8)
    v_mfma_f32_16x16x32_bf16 v[224:227], v[64:67], v[16:19], 0
    v_mfma_f32_16x16x32_bf16 v[224:227], v[68:71], v[20:23], v[224:227]
    v_mfma_f32_16x16x32_bf16 v[224:227], v[72:75], v[24:27], v[224:227]
    v_mfma_f32_16x16x32_bf16 v[224:227], v[76:79], v[28:31], v[224:227]
    v_mfma_f32_16x16x32_bf16 v[228:231], v[80:83], v[16:19], 0
    v_mfma_f32_16x16x32_bf16 v[228:231], v[84:87], v[20:23], v[228:231]
    v_mfma_f32_16x16x32_bf16 v[228:231], v[88:91], v[24:27], v[228:231]
    v_mfma_f32_16x16x32_bf16 v[228:231], v[92:95], v[28:31], v[228:231]
    s_nop 7
    s_nop 3
    v_cvt_pk_bf16_f32 v239, v224, v225
    v_lshlrev_b32 v224, 16, v239
    v_and_b32 v225, 0xffff0000, v239
    v_mul_f32 v224, s30, v224
    v_mul_f32 v225, s30, v225
    v_cvt_pk_bf16_f32 v239, v224, v225
    v_lshlrev_b32 v224, 16, v239
    v_and_b32 v225, 0xffff0000, v239
    v_cvt_pk_bf16_f32 v239, v226, v227
    v_lshlrev_b32 v226, 16, v239
    v_and_b32 v227, 0xffff0000, v239
    v_mul_f32 v226, s30, v226
    v_mul_f32 v227, s30, v227
    v_cvt_pk_bf16_f32 v239, v226, v227
    v_lshlrev_b32 v226, 16, v239
    v_and_b32 v227, 0xffff0000, v239
    v_cvt_pk_bf16_f32 v239, v228, v229
    v_lshlrev_b32 v228, 16, v239
    v_and_b32 v229, 0xffff0000, v239
    v_mul_f32 v228, s30, v228
    v_mul_f32 v229, s30, v229
    v_cvt_pk_bf16_f32 v239, v228, v229
    v_lshlrev_b32 v228, 16, v239
    v_and_b32 v229, 0xffff0000, v239
    v_cvt_pk_bf16_f32 v239, v230, v231
    v_lshlrev_b32 v230, 16, v239
    v_and_b32 v231, 0xffff0000, v239
    v_mul_f32 v230, s30, v230
    v_mul_f32 v231, s30, v231
    v_cvt_pk_bf16_f32 v239, v230, v231
    v_lshlrev_b32 v230, 16, v239
    v_and_b32 v231, 0xffff0000, v239
    v_max3_f32 v239, v224, v225, v226
    v_max3_f32 v239, v239, v227, v228
    v_max3_f32 v239, v239, v229, v230
    v_max_f32 v239, v239, v231
    v_mov_b32 v240, v239
    s_nop 1
    v_permlane16_swap_b32 v239, v240
    s_nop 1
    v_max_f32 v239, v239, v240
    v_mov_b32 v240, v239
    s_nop 1
    v_permlane32_swap_b32 v239, v240
    s_nop 1
    v_max3_f32 v243, v239, v240, v236
    v_sub_f32 v238, v236, v243
    v_mul_f32 v238, s31, v238
    v_exp_f32 v238, v238
    v_mov_b32 v236, v243
    v_mul_f32 v241, s31, v243
    v_fma_f32 v224, v224, s31, -v241
    v_fma_f32 v225, v225, s31, -v241
    v_fma_f32 v226, v226, s31, -v241
    v_fma_f32 v227, v227, s31, -v241
    v_fma_f32 v228, v228, s31, -v241
    v_fma_f32 v229, v229, s31, -v241
    v_fma_f32 v230, v230, s31, -v241
    v_fma_f32 v231, v231, s31, -v241
    v_exp_f32 v224, v224
    v_exp_f32 v225, v225
    v_exp_f32 v226, v226
    v_exp_f32 v227, v227
    v_exp_f32 v228, v228
    v_exp_f32 v229, v229
    v_exp_f32 v230, v230
    v_exp_f32 v231, v231
    s_nop 0
    v_add_f32 v239, v224, v225
    v_add_f32 v240, v226, v227
    v_add_f32 v241, v228, v229
    v_add_f32 v242, v230, v231
    v_add_f32 v239, v239, v240
    v_add_f32 v241, v241, v242
    v_add_f32 v239, v239, v241
    v_fma_f32 v237, v237, v238, v239
    v_cvt_pk_bf16_f32 v232, v224, v225
    v_cvt_pk_bf16_f32 v233, v226, v227
    v_cvt_pk_bf16_f32 v234, v228, v229
    v_cvt_pk_bf16_f32 v235, v230, v231
    v_mul_f32 v192, v238, v192
    v_mul_f32 v193, v238, v193
    v_mul_f32 v194, v238, v194
    v_mul_f32 v195, v238, v195
    v_mul_f32 v196, v238, v196
    v_mul_f32 v197, v238, v197
    v_mul_f32 v198, v238, v198
    v_mul_f32 v199, v238, v199
    v_mul_f32 v200, v238, v200
    v_mul_f32 v201, v238, v201
    v_mul_f32 v202, v238, v202
    v_mul_f32 v203, v238, v203
    v_mul_f32 v204, v238, v204
    v_mul_f32 v205, v238, v205
    v_mul_f32 v206, v238, v206
    v_mul_f32 v207, v238, v207
    v_mul_f32 v208, v238, v208
    v_mul_f32 v209, v238, v209
    v_mul_f32 v210, v238, v210
    v_mul_f32 v211, v238, v211
    v_mul_f32 v212, v238, v212
    v_mul_f32 v213, v238, v213
    v_mul_f32 v214, v238, v214
    v_mul_f32 v215, v238, v215
    v_mul_f32 v216, v238, v216
    v_mul_f32 v217, v238, v217
    v_mul_f32 v218, v238, v218
    v_mul_f32 v219, v238, v219
    v_mul_f32 v220, v238, v220
    v_mul_f32 v221, v238, v221
    v_mul_f32 v222, v238, v222
    v_mul_f32 v223, v238, v223
    s_waitcnt vmcnt(0)
    v_perm_b32 v160, v132, v128, s28
    v_perm_b32 v164, v132, v128, s29
    v_perm_b32 v161, v140, v136, s28
    v_perm_b32 v165, v140, v136, s29
    v_perm_b32 v162, v148, v144, s28
    v_perm_b32 v166, v148, v144, s29
    v_perm_b32 v163, v156, v152, s28
    v_perm_b32 v167, v156, v152, s29
    v_perm_b32 v168, v133, v129, s28
    v_perm_b32 v172, v133, v129, s29
    v_perm_b32 v169, v141, v137, s28
    v_perm_b32 v173, v141, v137, s29
    v_perm_b32 v170, v149, v145, s28
    v_perm_b32 v174, v149, v145, s29
    v_perm_b32 v171, v157, v153, s28
    v_perm_b32 v175, v157, v153, s29
    v_perm_b32 v176, v134, v130, s28
    v_perm_b32 v180, v134, v130, s29
    v_perm_b32 v177, v142, v138, s28
    v_perm_b32 v181, v142, v138, s29
    v_perm_b32 v178, v150, v146, s28
    v_perm_b32 v182, v150, v146, s29
    v_perm_b32 v179, v158, v154, s28
    v_perm_b32 v183, v158, v154, s29
    v_perm_b32 v184, v135, v131, s28
    v_perm_b32 v188, v135, v131, s29
    v_perm_b32 v185, v143, v139, s28
    v_perm_b32 v189, v143, v139, s29
    v_perm_b32 v186, v151, v147, s28
    v_perm_b32 v190, v151, v147, s29
    v_perm_b32 v187, v159, v155, s28
    v_perm_b32 v191, v159, v155, s29
    s_nop 1
    v_mfma_f32_16x16x32_bf16 v[192:195], v[160:163], v[232:235], v[192:195]
    v_mfma_f32_16x16x32_bf16 v[196:199], v[164:167], v[232:235], v[196:199]
    v_mfma_f32_16x16x32_bf16 v[200:203], v[168:171], v[232:235], v[200:203]
    v_mfma_f32_16x16x32_bf16 v[204:207], v[172:175], v[232:235], v[204:207]
    v_mfma_f32_16x16x32_bf16 v[208:211], v[176:179], v[232:235], v[208:211]
    v_mfma_f32_16x16x32_bf16 v[212:215], v[180:183], v[232:235], v[212:215]
    v_mfma_f32_16x16x32_bf16 v[216:219], v[184:187], v[232:235], v[216:219]
    v_mfma_f32_16x16x32_bf16 v[220:223], v[188:191], v[232:235], v[220:223]
    s_nop 7
    s_nop 3
    v_mov_b32 v240, v237
    s_nop 1
    v_permlane16_swap_b32 v237, v240
    s_nop 1
    v_add_f32 v237, v237, v240
    v_mov_b32 v240, v237
    s_nop 1
    v_permlane32_swap_b32 v237, v240
    s_nop 1
    v_add_f32 v237, v237, v240
    v_lshlrev_b32 v8, 11, v3
    v_lshl_add_u32 v8, v1, 9, v8
    v_lshl_add_u32 v8, v2, 7, v8
    v_lshlrev_b32 v9, 5, v3
    v_lshl_add_u32 v9, v1, 3, v9
    v_cmp_gt_u32 vcc, 4, v1
    s_and_saveexec_b64 s[52:53], vcc
    ds_write_b32 v8, v192 offset:0
    ds_write_b32 v8, v193 offset:32
    ds_write_b32 v8, v194 offset:64
    ds_write_b32 v8, v195 offset:96
    ds_write_b32 v8, v196 offset:4
    ds_write_b32 v8, v197 offset:36
    ds_write_b32 v8, v198 offset:68
    ds_write_b32 v8, v199 offset:100
    ds_write_b32 v8, v200 offset:8
    ds_write_b32 v8, v201 offset:40
    ds_write_b32 v8, v202 offset:72
    ds_write_b32 v8, v203 offset:104
    ds_write_b32 v8, v204 offset:12
    ds_write_b32 v8, v205 offset:44
    ds_write_b32 v8, v206 offset:76
    ds_write_b32 v8, v207 offset:108
    ds_write_b32 v8, v208 offset:16
    ds_write_b32 v8, v209 offset:48
    ds_write_b32 v8, v210 offset:80
    ds_write_b32 v8, v211 offset:112
    ds_write_b32 v8, v212 offset:20
    ds_write_b32 v8, v213 offset:52
    ds_write_b32 v8, v214 offset:84
    ds_write_b32 v8, v215 offset:116
    ds_write_b32 v8, v216 offset:24
    ds_write_b32 v8, v217 offset:56
    ds_write_b32 v8, v218 offset:88
    ds_write_b32 v8, v219 offset:120
    ds_write_b32 v8, v220 offset:28
    ds_write_b32 v8, v221 offset:60
    ds_write_b32 v8, v222 offset:92
    ds_write_b32 v8, v223 offset:124
    v_mov_b32 v10, v236
    v_mov_b32 v11, v237
    ds_write_b64 v9, v[10:11] offset:16384
    s_mov_b64 exec, s[52:53]
    s_waitcnt lgkmcnt(0)
    s_barrier
    v_lshrrev_b32 v1, 7, v0
    v_and_b32 v2, 127, v0
    v_lshlrev_b32 v3, 3, v1
    ds_read_b64 v[16:17], v3 offset:16384
    ds_read_b64 v[18:19], v3 offset:16416
    ds_read_b64 v[20:21], v3 offset:16448
    ds_read_b64 v[22:23], v3 offset:16480
    ds_read_b64 v[24:25], v3 offset:16512
    ds_read_b64 v[26:27], v3 offset:16544
    ds_read_b64 v[28:29], v3 offset:16576
    ds_read_b64 v[30:31], v3 offset:16608
    v_lshlrev_b32 v4, 9, v1
    v_lshl_add_u32 v4, v2, 2, v4
    ds_read_b32 v32, v4 offset:0
    ds_read_b32 v33, v4 offset:2048
    ds_read_b32 v34, v4 offset:4096
    ds_read_b32 v35, v4 offset:6144
    ds_read_b32 v36, v4 offset:8192
    ds_read_b32 v37, v4 offset:10240
    ds_read_b32 v38, v4 offset:12288
    ds_read_b32 v39, v4 offset:14336
    s_waitcnt lgkmcnt(0)
    v_max3_f32 v5, v16, v18, v20
    v_max3_f32 v5, v5, v22, v24
    v_max3_f32 v5, v5, v26, v28
    v_max_f32 v5, v5, v30
    v_mov_b32 v6, 0
    v_mov_b32 v7, 0
    v_sub_f32 v8, v16, v5
    v_mul_f32 v8, s31, v8
    v_exp_f32 v8, v8
    s_nop 0
    v_fmac_f32 v6, v8, v32
    v_fmac_f32 v7, v8, v17
    v_sub_f32 v8, v18, v5
    v_mul_f32 v8, s31, v8
    v_exp_f32 v8, v8
    s_nop 0
    v_fmac_f32 v6, v8, v33
    v_fmac_f32 v7, v8, v19
    v_sub_f32 v8, v20, v5
    v_mul_f32 v8, s31, v8
    v_exp_f32 v8, v8
    s_nop 0
    v_fmac_f32 v6, v8, v34
    v_fmac_f32 v7, v8, v21
    v_sub_f32 v8, v22, v5
    v_mul_f32 v8, s31, v8
    v_exp_f32 v8, v8
    s_nop 0
    v_fmac_f32 v6, v8, v35
    v_fmac_f32 v7, v8, v23
    v_sub_f32 v8, v24, v5
    v_mul_f32 v8, s31, v8
    v_exp_f32 v8, v8
    s_nop 0
    v_fmac_f32 v6, v8, v36
    v_fmac_f32 v7, v8, v25
    v_sub_f32 v8, v26, v5
    v_mul_f32 v8, s31, v8
    v_exp_f32 v8, v8
    s_nop 0
    v_fmac_f32 v6, v8, v37
    v_fmac_f32 v7, v8, v27
    v_sub_f32 v8, v28, v5
    v_mul_f32 v8, s31, v8
    v_exp_f32 v8, v8
    s_nop 0
    v_fmac_f32 v6, v8, v38
    v_fmac_f32 v7, v8, v29
    v_sub_f32 v8, v30, v5
    v_mul_f32 v8, s31, v8
    v_exp_f32 v8, v8
    s_nop 0
    v_fmac_f32 v6, v8, v39
    v_fmac_f32 v7, v8, v31
    s_lshl_b32 s12, s10, 7
    s_add_u32 s12, s12, s11
    v_lshlrev_b32 v9, 5, v1
    v_add_u32 v9, s12, v9
    v_lshlrev_b32 v10, 9, v9
    v_lshl_add_u32 v10, v2, 2, v10
    s_mov_b32 s13, 65536
    buffer_store_dword v6, v10, s[24:27], s13 offen
    v_cmp_eq_u32 vcc, 0, v2
    s_and_saveexec_b64 s[52:53], vcc
    v_lshlrev_b32 v10, 3, v9
    v_mov_b32 v6, v5
    s_mov_b32 s13, 589824
    buffer_store_dwordx2 v[6:7], v10, s[24:27], s13 offen
k2_end:
    s_endpgm
.section .rodata,"a"
.p2align 6
.amdhsa_kernel k2_attn_kernel
  .amdhsa_next_free_vgpr 244
  .amdhsa_next_free_sgpr 102
  .amdhsa_accum_offset 244
  .amdhsa_group_segment_fixed_size 0
  .amdhsa_kernarg_size 104
  .amdhsa_user_sgpr_count 2
  .amdhsa_user_sgpr_kernarg_segment_ptr 1
  .amdhsa_system_sgpr_workgroup_id_x 1
.end_amdhsa_kernel
.text
.globl k3_tail_kernel
.p2align 8
.type k3_tail_kernel,@function
k3_tail_kernel:
    s_cmp_ge_u32 s2, 128
    s_cbranch_scc1 k3_end
    s_load_dwordx16 s[64:79], s[0:1], 0
    s_load_dwordx8 s[80:87], s[0:1], 64
    s_load_dwordx2 s[88:89], s[0:1], 96
    v_readfirstlane_b32 s3, v0
    s_nop 3
    s_lshr_b32 s3, s3, 6
    s_mov_b32 s31, 1069066811
    s_mov_b32 s33, 0x3b000000
    v_lshrrev_b32 v3, 6, v0
    s_waitcnt lgkmcnt(0)
    s_mov_b32 s24, s88
    s_and_b32 s25, s89, 0xffff
    s_mov_b32 s26, 536870912
    s_mov_b32 s27, 0x00020000
    s_cmp_lt_u32 s2, 64
    s_cbranch_scc1 r_wo
    s_cmp_lt_u32 s2, 120
    s_cbranch_scc1 r_ffn
    s_branch r_fin
r_wo:
    s_lshr_b32 s14, s2, 3
    s_and_b32 s15, s2, 7
    v_lshrrev_b32 v1, 7, v0
    v_and_b32 v2, 127, v0
    s_lshl_b32 s12, s14, 2
    v_add_u32 v6, s12, v1
    v_and_b32 v7, 31, v0
    v_lshlrev_b32 v8, 8, v6
    v_lshl_add_u32 v8, v7, 3, v8
    s_mov_b32 s13, 589824
    buffer_load_dwordx2 v[10:11], v8, s[24:27], s13 offen
    v_lshlrev_b32 v8, 14, v6
    v_lshl_add_u32 v8, v2, 2, v8
    s_mov_b32 s56, 65536
    s_mov_b32 s57, 69632
    s_mov_b32 s58, 73728
    s_mov_b32 s59, 77824
    buffer_load_dword v64, v8, s[24:27], s56 offen offset:0
    buffer_load_dword v65, v8, s[24:27], s56 offen offset:512
    buffer_load_dword v66, v8, s[24:27], s56 offen offset:1024
    buffer_load_dword v67, v8, s[24:27], s56 offen offset:1536
    buffer_load_dword v68, v8, s[24:27], s56 offen offset:2048
    buffer_load_dword v69, v8, s[24:27], s56 offen offset:2560
    buffer_load_dword v70, v8, s[24:27], s56 offen offset:3072
    buffer_load_dword v71, v8, s[24:27], s56 offen offset:3584
    buffer_load_dword v72, v8, s[24:27], s57 offen offset:0
    buffer_load_dword v73, v8, s[24:27], s57 offen offset:512
    buffer_load_dword v74, v8, s[24:27], s57 offen offset:1024
    buffer_load_dword v75, v8, s[24:27], s57 offen offset:1536
    buffer_load_dword v76, v8, s[24:27], s57 offen offset:2048
    buffer_load_dword v77, v8, s[24:27], s57 offen offset:2560
    buffer_load_dword v78, v8, s[24:27], s57 offen offset:3072
    buffer_load_dword v79, v8, s[24:27], s57 offen offset:3584
    buffer_load_dword v80, v8, s[24:27], s58 offen offset:0
    buffer_load_dword v81, v8, s[24:27], s58 offen offset:512
    buffer_load_dword v82, v8, s[24:27], s58 offen offset:1024
    buffer_load_dword v83, v8, s[24:27], s58 offen offset:1536
    buffer_load_dword v84, v8, s[24:27], s58 offen offset:2048
    buffer_load_dword v85, v8, s[24:27], s58 offen offset:2560
    buffer_load_dword v86, v8, s[24:27], s58 offen offset:3072
    buffer_load_dword v87, v8, s[24:27], s58 offen offset:3584
    buffer_load_dword v88, v8, s[24:27], s59 offen offset:0
    buffer_load_dword v89, v8, s[24:27], s59 offen offset:512
    buffer_load_dword v90, v8, s[24:27], s59 offen offset:1024
    buffer_load_dword v91, v8, s[24:27], s59 offen offset:1536
    buffer_load_dword v92, v8, s[24:27], s59 offen offset:2048
    buffer_load_dword v93, v8, s[24:27], s59 offen offset:2560
    buffer_load_dword v94, v8, s[24:27], s59 offen offset:3072
    buffer_load_dword v95, v8, s[24:27], s59 offen offset:3584
    s_lshl_b32 s12, s14, 19
    s_lshl_b32 s13, s15, 7
    s_add_u32 s12, s12, s13
    s_mov_b32 s36, s72
    s_and_b32 s37, s73, 0xffff
    s_mov_b32 s38, 4194304
    s_mov_b32 s39, 0x00020000
    v_lshrrev_b32 v4, 3, v0
    v_and_b32 v5, 7, v0
    v_lshlrev_b32 v9, 13, v4
    v_lshl_add_u32 v9, v5, 4, v9
    s_add_u32 s13, s12, 4096
    buffer_load_dwordx4 v[32:35], v9, s[36:39], s12 offen offset:0
    buffer_load_dwordx4 v[36:39], v9, s[36:39], s12 offen offset:1024
    buffer_load_dwordx4 v[40:43], v9, s[36:39], s12 offen offset:2048
    buffer_load_dwordx4 v[44:47], v9, s[36:39], s12 offen offset:3072
    buffer_load_dwordx4 v[48:51], v9, s[36:39], s13 offen offset:0
    buffer_load_dwordx4 v[52:55], v9, s[36:39], s13 offen offset:1024
    buffer_load_dwordx4 v[56:59], v9, s[36:39], s13 offen offset:2048
    buffer_load_dwordx4 v[60:63], v9, s[36:39], s13 offen offset:3072
    s_waitcnt vmcnt(40)
    v_mov_b32 v12, v10
    s_nop 1
    v_max_f32_dpp v12, v12, v12 quad_perm:[1,0,3,2] row_mask:0xf bank_mask:0xf
    s_nop 1
    v_max_f32_dpp v12, v12, v12 quad_perm:[2,3,0,1] row_mask:0xf bank_mask:0xf
    s_nop 1
    v_max_f32_dpp v12, v12, v12 row_half_mirror row_mask:0xf bank_mask:0xf
    s_nop 1
    v_max_f32_dpp v12, v12, v12 row_mirror row_mask:0xf bank_mask:0xf
    v_mov_b32 v13, v12
    s_nop 1
    v_permlane16_swap_b32 v12, v13
    s_nop 1
    v_max_f32 v12, v12, v13
    v_sub_f32 v13, v10, v12
    v_mul_f32 v13, s31, v13
    v_exp_f32 v13, v13
    s_nop 0
    v_mul_f32 v14, v13, v11
    s_nop 1
    v_add_f32_dpp v14, v14, v14 quad_perm:[1,0,3,2] row_mask:0xf bank_mask:0xf
    s_nop 1
    v_add_f32_dpp v14, v14, v14 quad_perm:[2,3,0,1] row_mask:0xf bank_mask:0xf
    s_nop 1
    v_add_f32_dpp v14, v14, v14 row_half_mirror row_mask:0xf bank_mask:0xf
    s_nop 1
    v_add_f32_dpp v14, v14, v14 row_mirror row_mask:0xf bank_mask:0xf
    v_mov_b32 v15, v14
    s_nop 1
    v_permlane16_swap_b32 v14, v15
    s_nop 1
    v_add_f32 v14, v14, v15
    v_mov_b32 v16, 0
    s_waitcnt vmcnt(8)
    v_readlane_b32 s40, v13, 0
    v_readlane_b32 s41, v13, 1
    v_readlane_b32 s42, v13, 2
    v_readlane_b32 s43, v13, 3
    v_readlane_b32 s44, v13, 4
    v_readlane_b32 s45, v13, 5
    v_readlane_b32 s46, v13, 6
    v_readlane_b32 s47, v13, 7
    s_nop 1
    v_fmac_f32 v16, s40, v64
    v_fmac_f32 v16, s41, v65
    v_fmac_f32 v16, s42, v66
    v_fmac_f32 v16, s43, v67
    v_fmac_f32 v16, s44, v68
    v_fmac_f32 v16, s45, v69
    v_fmac_f32 v16, s46, v70
    v_fmac_f32 v16, s47, v71
    v_readlane_b32 s40, v13, 8
    v_readlane_b32 s41, v13, 9
    v_readlane_b32 s42, v13, 10
    v_readlane_b32 s43, v13, 11
    v_readlane_b32 s44, v13, 12
    v_readlane_b32 s45, v13, 13
    v_readlane_b32 s46, v13, 14
    v_readlane_b32 s47, v13, 15
    s_nop 1
    v_fmac_f32 v16, s40, v72
    v_fmac_f32 v16, s41, v73
    v_fmac_f32 v16, s42, v74
    v_fmac_f32 v16, s43, v75
    v_fmac_f32 v16, s44, v76
    v_fmac_f32 v16, s45, v77
    v_fmac_f32 v16, s46, v78
    v_fmac_f32 v16, s47, v79
    v_readlane_b32 s40, v13, 16
    v_readlane_b32 s41, v13, 17
    v_readlane_b32 s42, v13, 18
    v_readlane_b32 s43, v13, 19
    v_readlane_b32 s44, v13, 20
    v_readlane_b32 s45, v13, 21
    v_readlane_b32 s46, v13, 22
    v_readlane_b32 s47, v13, 23
    s_nop 1
    v_fmac_f32 v16, s40, v80
    v_fmac_f32 v16, s41, v81
    v_fmac_f32 v16, s42, v82
    v_fmac_f32 v16, s43, v83
    v_fmac_f32 v16, s44, v84
    v_fmac_f32 v16, s45, v85
    v_fmac_f32 v16, s46, v86
    v_fmac_f32 v16, s47, v87
    v_readlane_b32 s40, v13, 24
    v_readlane_b32 s41, v13, 25
    v_readlane_b32 s42, v13, 26
    v_readlane_b32 s43, v13, 27
    v_readlane_b32 s44, v13, 28
    v_readlane_b32 s45, v13, 29
    v_readlane_b32 s46, v13, 30
    v_readlane_b32 s47, v13, 31
    s_nop 1
    v_fmac_f32 v16, s40, v88
    v_fmac_f32 v16, s41, v89
    v_fmac_f32 v16, s42, v90
    v_fmac_f32 v16, s43, v91
    v_fmac_f32 v16, s44, v92
    v_fmac_f32 v16, s45, v93
    v_fmac_f32 v16, s46, v94
    v_fmac_f32 v16, s47, v95
    v_rcp_f32 v15, v14
    s_nop 0
    v_mul_f32 v17, v16, v15
    v_fma_f32 v18, -v17, v14, v16
    v_fma_f32 v16, v18, v15, v17
    v_cvt_pk_bf16_f32 v16, v16, v16
    v_lshlrev_b32 v16, 16, v16
    v_lshlrev_b32 v8, 2, v0
    ds_write_b32 v8, v16
    s_waitcnt lgkmcnt(0)
    s_barrier
    v_lshlrev_b32 v8, 5, v4
    ds_read_b128 v[16:19], v8
    ds_read_b128 v[20:23], v8 offset:16
    v_mov_b32 v64, 0
    v_mov_b32 v65, 0
    v_mov_b32 v66, 0
    v_mov_b32 v67, 0
    v_mov_b32 v68, 0
    v_mov_b32 v69, 0
    v_mov_b32 v70, 0
    v_mov_b32 v71, 0
    s_waitcnt lgkmcnt(0) vmcnt(0)
    v_lshlrev_b32 v28, 16, v32
    v_and_b32 v29, 0xffff0000, v32
    v_fmac_f32 v64, v16, v28
    v_fmac_f32 v65, v16, v29
    v_lshlrev_b32 v28, 16, v33
    v_and_b32 v29, 0xffff0000, v33
    v_fmac_f32 v66, v16, v28
    v_fmac_f32 v67, v16, v29
    v_lshlrev_b32 v28, 16, v34
    v_and_b32 v29, 0xffff0000, v34
    v_fmac_f32 v68, v16, v28
    v_fmac_f32 v69, v16, v29
    v_lshlrev_b32 v28, 16, v35
    v_and_b32 v29, 0xffff0000, v35
    v_fmac_f32 v70, v16, v28
    v_fmac_f32 v71, v16, v29
    v_lshlrev_b32 v28, 16, v36
    v_and_b32 v29, 0xffff0000, v36
    v_fmac_f32 v64, v17, v28
    v_fmac_f32 v65, v17, v29
    v_lshlrev_b32 v28, 16, v37
    v_and_b32 v29, 0xffff0000, v37
    v_fmac_f32 v66, v17, v28
    v_fmac_f32 v67, v17, v29
    v_lshlrev_b32 v28, 16, v38
    v_and_b32 v29, 0xffff0000, v38
    v_fmac_f32 v68, v17, v28
    v_fmac_f32 v69, v17, v29
    v_lshlrev_b32 v28, 16, v39
    v_and_b32 v29, 0xffff0000, v39
    v_fmac_f32 v70, v17, v28
    v_fmac_f32 v71, v17, v29
    v_lshlrev_b32 v28, 16, v40
    v_and_b32 v29, 0xffff0000, v40
    v_fmac_f32 v64, v18, v28
    v_fmac_f32 v65, v18, v29
    v_lshlrev_b32 v28, 16, v41
    v_and_b32 v29, 0xffff0000, v41
    v_fmac_f32 v66, v18, v28
    v_fmac_f32 v67, v18, v29
    v_lshlrev_b32 v28, 16, v42
    v_and_b32 v29, 0xffff0000, v42
    v_fmac_f32 v68, v18, v28
    v_fmac_f32 v69, v18, v29
    v_lshlrev_b32 v28, 16, v43
    v_and_b32 v29, 0xffff0000, v43
    v_fmac_f32 v70, v18, v28
    v_fmac_f32 v71, v18, v29
    v_lshlrev_b32 v28, 16, v44
    v_and_b32 v29, 0xffff0000, v44
    v_fmac_f32 v64, v19, v28
    v_fmac_f32 v65, v19, v29
    v_lshlrev_b32 v28, 16, v45
    v_and_b32 v29, 0xffff0000, v45
    v_fmac_f32 v66, v19, v28
    v_fmac_f32 v67, v19, v29
    v_lshlrev_b32 v28, 16, v46
    v_and_b32 v29, 0xffff0000, v46
    v_fmac_f32 v68, v19, v28
    v_fmac_f32 v69, v19, v29
    v_lshlrev_b32 v28, 16, v47
    v_and_b32 v29, 0xffff0000, v47
    v_fmac_f32 v70, v19, v28
    v_fmac_f32 v71, v19, v29
    v_lshlrev_b32 v28, 16, v48
    v_and_b32 v29, 0xffff0000, v48
    v_fmac_f32 v64, v20, v28
    v_fmac_f32 v65, v20, v29
    v_lshlrev_b32 v28, 16, v49
    v_and_b32 v29, 0xffff0000, v49
    v_fmac_f32 v66, v20, v28
    v_fmac_f32 v67, v20, v29
    v_lshlrev_b32 v28, 16, v50
    v_and_b32 v29, 0xffff0000, v50
    v_fmac_f32 v68, v20, v28
    v_fmac_f32 v69, v20, v29
    v_lshlrev_b32 v28, 16, v51
    v_and_b32 v29, 0xffff0000, v51
    v_fmac_f32 v70, v20, v28
    v_fmac_f32 v71, v20, v29
    v_lshlrev_b32 v28, 16, v52
    v_and_b32 v29, 0xffff0000, v52
    v_fmac_f32 v64, v21, v28
    v_fmac_f32 v65, v21, v29
    v_lshlrev_b32 v28, 16, v53
    v_and_b32 v29, 0xffff0000, v53
    v_fmac_f32 v66, v21, v28
    v_fmac_f32 v67, v21, v29
    v_lshlrev_b32 v28, 16, v54
    v_and_b32 v29, 0xffff0000, v54
    v_fmac_f32 v68, v21, v28
    v_fmac_f32 v69, v21, v29
    v_lshlrev_b32 v28, 16, v55
    v_and_b32 v29, 0xffff0000, v55
    v_fmac_f32 v70, v21, v28
    v_fmac_f32 v71, v21, v29
    v_lshlrev_b32 v28, 16, v56
    v_and_b32 v29, 0xffff0000, v56
    v_fmac_f32 v64, v22, v28
    v_fmac_f32 v65, v22, v29
    v_lshlrev_b32 v28, 16, v57
    v_and_b32 v29, 0xffff0000, v57
    v_fmac_f32 v66, v22, v28
    v_fmac_f32 v67, v22, v29
    v_lshlrev_b32 v28, 16, v58
    v_and_b32 v29, 0xffff0000, v58
    v_fmac_f32 v68, v22, v28
    v_fmac_f32 v69, v22, v29
    v_lshlrev_b32 v28, 16, v59
    v_and_b32 v29, 0xffff0000, v59
    v_fmac_f32 v70, v22, v28
    v_fmac_f32 v71, v22, v29
    v_lshlrev_b32 v28, 16, v60
    v_and_b32 v29, 0xffff0000, v60
    v_fmac_f32 v64, v23, v28
    v_fmac_f32 v65, v23, v29
    v_lshlrev_b32 v28, 16, v61
    v_and_b32 v29, 0xffff0000, v61
    v_fmac_f32 v66, v23, v28
    v_fmac_f32 v67, v23, v29
    v_lshlrev_b32 v28, 16, v62
    v_and_b32 v29, 0xffff0000, v62
    v_fmac_f32 v68, v23, v28
    v_fmac_f32 v69, v23, v29
    v_lshlrev_b32 v28, 16, v63
    v_and_b32 v29, 0xffff0000, v63
    v_fmac_f32 v70, v23, v28
    v_fmac_f32 v71, v23, v29
    s_nop 1
    v_add_f32_dpp v64, v64, v64 row_ror:8 row_mask:0xf bank_mask:0xf
    v_mov_b32 v28, v64
    s_nop 1
    v_permlane16_swap_b32 v64, v28
    s_nop 1
    v_add_f32 v64, v64, v28
    v_mov_b32 v28, v64
    s_nop 1
    v_permlane32_swap_b32 v64, v28
    s_nop 1
    v_add_f32 v64, v64, v28
    s_nop 1
    v_add_f32_dpp v65, v65, v65 row_ror:8 row_mask:0xf bank_mask:0xf
    v_mov_b32 v28, v65
    s_nop 1
    v_permlane16_swap_b32 v65, v28
    s_nop 1
    v_add_f32 v65, v65, v28
    v_mov_b32 v28, v65
    s_nop 1
    v_permlane32_swap_b32 v65, v28
    s_nop 1
    v_add_f32 v65, v65, v28
    s_nop 1
    v_add_f32_dpp v66, v66, v66 row_ror:8 row_mask:0xf bank_mask:0xf
    v_mov_b32 v28, v66
    s_nop 1
    v_permlane16_swap_b32 v66, v28
    s_nop 1
    v_add_f32 v66, v66, v28
    v_mov_b32 v28, v66
    s_nop 1
    v_permlane32_swap_b32 v66, v28
    s_nop 1
    v_add_f32 v66, v66, v28
    s_nop 1
    v_add_f32_dpp v67, v67, v67 row_ror:8 row_mask:0xf bank_mask:0xf
    v_mov_b32 v28, v67
    s_nop 1
    v_permlane16_swap_b32 v67, v28
    s_nop 1
    v_add_f32 v67, v67, v28
    v_mov_b32 v28, v67
    s_nop 1
    v_permlane32_swap_b32 v67, v28
    s_nop 1
    v_add_f32 v67, v67, v28
    s_nop 1
    v_add_f32_dpp v68, v68, v68 row_ror:8 row_mask:0xf bank_mask:0xf
    v_mov_b32 v28, v68
    s_nop 1
    v_permlane16_swap_b32 v68, v28
    s_nop 1
    v_add_f32 v68, v68, v28
    v_mov_b32 v28, v68
    s_nop 1
    v_permlane32_swap_b32 v68, v28
    s_nop 1
    v_add_f32 v68, v68, v28
    s_nop 1
    v_add_f32_dpp v69, v69, v69 row_ror:8 row_mask:0xf bank_mask:0xf
    v_mov_b32 v28, v69
    s_nop 1
    v_permlane16_swap_b32 v69, v28
    s_nop 1
    v_add_f32 v69, v69, v28
    v_mov_b32 v28, v69
    s_nop 1
    v_permlane32_swap_b32 v69, v28
    s_nop 1
    v_add_f32 v69, v69, v28
    s_nop 1
    v_add_f32_dpp v70, v70, v70 row_ror:8 row_mask:0xf bank_mask:0xf
    v_mov_b32 v28, v70
    s_nop 1
    v_permlane16_swap_b32 v70, v28
    s_nop 1
    v_add_f32 v70, v70, v28
    v_mov_b32 v28, v70
    s_nop 1
    v_permlane32_swap_b32 v70, v28
    s_nop 1
    v_add_f32 v70, v70, v28
    s_nop 1
    v_add_f32_dpp v71, v71, v71 row_ror:8 row_mask:0xf bank_mask:0xf
    v_mov_b32 v28, v71
    s_nop 1
    v_permlane16_swap_b32 v71, v28
    s_nop 1
    v_add_f32 v71, v71, v28
    v_mov_b32 v28, v71
    s_nop 1
    v_permlane32_swap_b32 v71, v28
    s_nop 1
    v_add_f32 v71, v71, v28
    v_lshlrev_b32 v6, 8, v3
    v_lshl_add_u32 v6, v5, 5, v6
    v_and_b32 v8, 63, v0
    v_cmp_gt_u32 vcc, 8, v8
    s_and_saveexec_b64 s[52:53], vcc
    ds_write_b128 v6, v[64:67] offset:4096
    ds_write_b128 v6, v[68:71] offset:4112
    s_mov_b64 exec, s[52:53]
    s_waitcnt lgkmcnt(0)
    s_barrier
    s_cmp_lg_u32 s3, 0
    s_cbranch_scc1 k3_end
    v_lshlrev_b32 v6, 2, v0
    ds_read_b32 v8, v6 offset:4096
    ds_read_b32 v9, v6 offset:4352
    ds_read_b32 v10, v6 offset:4608
    ds_read_b32 v11, v6 offset:4864
    ds_read_b32 v12, v6 offset:5120
    ds_read_b32 v13, v6 offset:5376
    ds_read_b32 v14, v6 offset:5632
    ds_read_b32 v15, v6 offset:5888
    s_waitcnt lgkmcnt(0)
    v_add_f32 v8, v8, v9
    v_add_f32 v10, v10, v11
    v_add_f32 v12, v12, v13
    v_add_f32 v14, v14, v15
    v_add_f32 v8, v8, v10
    v_add_f32 v12, v12, v14
    v_add_f32 v8, v8, v12
    v_mov_b32 v9, 1
    v_lshlrev_b32 v6, 3, v0
    s_lshl_b32 s12, s14, 12
    s_lshl_b32 s13, s15, 9
    s_add_u32 s12, s12, s13
    s_add_u32 s12, s12, 598016
    buffer_store_dwordx2 v[8:9], v6, s[24:27], s12 offen sc1
    s_branch k3_end
r_ffn:
    s_sub_u32 s14, s2, 64
    s_mov_b32 s36, s76
    s_and_b32 s37, s77, 0xffff
    s_mov_b32 s38, 1835008
    s_mov_b32 s39, 0x00020000
    s_mov_b32 s92, s80
    s_and_b32 s93, s81, 0xffff
    s_mov_b32 s94, 1835008
    s_mov_b32 s95, 0x00020000
    v_lshrrev_b32 v4, 2, v0
    v_and_b32 v5, 3, v0
    s_mov_b32 s12, 14336
    v_mul_lo_u32 v6, v4, s12
    v_lshl_add_u32 v6, v5, 4, v6
    s_lshl_b32 s12, s14, 6
    buffer_load_dwordx4 v[32:35], v6, s[36:39], s12 offen
    buffer_load_dwordx4 v[36:39], v6, s[36:39], s12 offen offset:3584
    s_add_u32 s13, s12, 7168
    buffer_load_dwordx4 v[40:43], v6, s[36:39], s13 offen
    buffer_load_dwordx4 v[44:47], v6, s[36:39], s13 offen offset:3584
    v_lshlrev_b32 v6, 10, v3
    v_and_b32 v7, 63, v0
    v_lshl_add_u32 v6, v7, 4, v6
    s_lshl_b32 s12, s14, 15
    s_add_u32 s13, s12, 0
    buffer_load_dwordx4 v[48:51], v6, s[92:95], s13 offen
    s_add_u32 s13, s12, 8192
    buffer_load_dwordx4 v[52:55], v6, s[92:95], s13 offen
    s_add_u32 s13, s12, 16384
    buffer_load_dwordx4 v[56:59], v6, s[92:95], s13 offen
    s_add_u32 s13, s12, 24576
    buffer_load_dwordx4 v[60:63], v6, s[92:95], s13 offen
    s_mov_b32 s36, s64
    s_and_b32 s37, s65, 0xffff
    s_mov_b32 s38, 1024
    s_mov_b32 s39, 0x00020000
    s_mov_b32 s92, s78
    s_and_b32 s93, s79, 0xffff
    s_mov_b32 s94, 3584
    s_mov_b32 s95, 0x00020000
    v_lshlrev_b32 v6, 1, v0
    buffer_load_ushort v12, v6, s[36:39], 0 offen
    v_and_b32 v7, 31, v0
    v_lshlrev_b32 v7, 1, v7
    s_lshl_b32 s12, s14, 6
    buffer_load_ushort v15, v7, s[92:95], s12 offen
    v_lshlrev_b32 v8, 3, v0
    s_mov_b32 s56, 598016
    s_mov_b32 s57, 602112
    s_mov_b32 s58, 606208
    s_mov_b32 s59, 610304
    s_mov_b32 s60, 614400
    s_mov_b32 s61, 618496
    s_mov_b32 s62, 622592
    s_mov_b32 s63, 626688
    s_mov_b32 s50, 0
pf_loop:
    buffer_load_dwordx2 v[64:65], v8, s[24:27], s56 offen sc1
    buffer_load_dwordx2 v[66:67], v8, s[24:27], s57 offen sc1
    buffer_load_dwordx2 v[68:69], v8, s[24:27], s58 offen sc1
    buffer_load_dwordx2 v[70:71], v8, s[24:27], s59 offen sc1
    buffer_load_dwordx2 v[72:73], v8, s[24:27], s60 offen sc1
    buffer_load_dwordx2 v[74:75], v8, s[24:27], s61 offen sc1
    buffer_load_dwordx2 v[76:77], v8, s[24:27], s62 offen sc1
    buffer_load_dwordx2 v[78:79], v8, s[24:27], s63 offen sc1
    s_waitcnt vmcnt(0)
    v_and_b32 v9, v65, v67
    v_and_b32 v9, v9, v69
    v_and_b32 v9, v9, v71
    v_and_b32 v9, v9, v73
    v_and_b32 v9, v9, v75
    v_and_b32 v9, v9, v77
    v_and_b32 v9, v9, v79
    v_cmp_eq_u32 vcc, 1, v9
    s_add_u32 s50, s50, 1
    s_nop 1
    s_cmp_eq_u64 vcc, exec
    s_cbranch_scc1 pf_done
    s_cmp_lt_u32 s50, 400000
    s_cbranch_scc1 pf_loop
pf_done:
    v_mov_b32 v16, v64
    v_mov_b32 v17, v66
    v_mov_b32 v18, v68
    v_mov_b32 v19, v70
    v_mov_b32 v20, v72
    v_mov_b32 v21, v74
    v_mov_b32 v22, v76
    v_mov_b32 v23, v78
    v_add_f32 v16, v16, v17
    v_add_f32 v18, v18, v19
    v_add_f32 v20, v20, v21
    v_add_f32 v22, v22, v23
    v_add_f32 v16, v16, v18
    v_add_f32 v20, v20, v22
    v_add_f32 v10, v16, v20
    v_cvt_pk_bf16_f32 v10, v10, v10
    v_lshlrev_b32 v10, 16, v10
    v_lshlrev_b32 v12, 16, v12
    v_add_f32 v10, v10, v12
    v_cvt_pk_bf16_f32 v10, v10, v10
    v_lshlrev_b32 v10, 16, v10
    v_mov_b32 v11, v10
    s_nop 1
    v_add_f32_dpp v11, v11, v11 quad_perm:[1,0,3,2] row_mask:0xf bank_mask:0xf
    s_nop 1
    v_add_f32_dpp v11, v11, v11 quad_perm:[2,3,0,1] row_mask:0xf bank_mask:0xf
    s_nop 1
    v_add_f32_dpp v11, v11, v11 row_half_mirror row_mask:0xf bank_mask:0xf
    s_nop 1
    v_add_f32_dpp v11, v11, v11 row_mirror row_mask:0xf bank_mask:0xf
    v_mov_b32 v13, v11
    s_nop 1
    v_permlane16_swap_b32 v11, v13
    s_nop 1
    v_add_f32 v11, v11, v13
    v_mov_b32 v13, v11
    s_nop 1
    v_permlane32_swap_b32 v11, v13
    s_nop 1
    v_add_f32 v11, v11, v13
    v_lshlrev_b32 v14, 2, v3
    ds_write_b32 v14, v11 offset:4096
    s_waitcnt lgkmcnt(0)
    s_barrier
    v_mov_b32 v13, 0
    ds_read_b128 v[16:19], v13 offset:4096
    ds_read_b128 v[20:23], v13 offset:4112
    s_waitcnt lgkmcnt(0)
    v_add_f32 v16, v16, v17
    v_add_f32 v18, v18, v19
    v_add_f32 v20, v20, v21
    v_add_f32 v22, v22, v23
    v_add_f32 v16, v16, v18
    v_add_f32 v20, v20, v22
    v_add_f32 v11, v16, v20
    v_mul_f32 v11, s33, v11
    v_sub_f32 v13, v10, v11
    v_mul_f32 v24, v13, v13
    s_nop 1
    v_add_f32_dpp v24, v24, v24 quad_perm:[1,0,3,2] row_mask:0xf bank_mask:0xf
    s_nop 1
    v_add_f32_dpp v24, v24, v24 quad_perm:[2,3,0,1] row_mask:0xf bank_mask:0xf
    s_nop 1
    v_add_f32_dpp v24, v24, v24 row_half_mirror row_mask:0xf bank_mask:0xf
    s_nop 1
    v_add_f32_dpp v24, v24, v24 row_mirror row_mask:0xf bank_mask:0xf
    v_mov_b32 v13, v24
    s_nop 1
    v_permlane16_swap_b32 v24, v13
    s_nop 1
    v_add_f32 v24, v24, v13
    v_mov_b32 v13, v24
    s_nop 1
    v_permlane32_swap_b32 v24, v13
    s_nop 1
    v_add_f32 v24, v24, v13
    ds_write_b32 v14, v24 offset:4160
    s_waitcnt lgkmcnt(0)
    s_barrier
    v_mov_b32 v13, 0
    ds_read_b128 v[16:19], v13 offset:4160
    ds_read_b128 v[20:23], v13 offset:4176
    s_waitcnt lgkmcnt(0)
    v_add_f32 v16, v16, v17
    v_add_f32 v18, v18, v19
    v_add_f32 v20, v20, v21
    v_add_f32 v22, v22, v23
    v_add_f32 v16, v16, v18
    v_add_f32 v20, v20, v22
    v_add_f32 v24, v16, v20
    v_mul_f32 v24, s33, v24
    v_cvt_pk_bf16_f32 v24, v24, v24
    v_lshlrev_b32 v24, 16, v24
    v_add_f32 v24, 0x3727c5ac, v24
    v_cvt_pk_bf16_f32 v24, v24, v24
    v_lshlrev_b32 v24, 16, v24
    v_sqrt_f32 v24, v24
    s_nop 0
    v_cvt_pk_bf16_f32 v24, v24, v24
    v_lshlrev_b32 v24, 16, v24
    v_cvt_pk_bf16_f32 v11, v11, v11
    v_lshlrev_b32 v11, 16, v11
    v_sub_f32 v10, v10, v11
    v_cvt_pk_bf16_f32 v10, v10, v10
    v_lshlrev_b32 v10, 16, v10
    v_rcp_f32 v25, v24
    s_nop 0
    v_mul_f32 v26, v10, v25
    v_fma_f32 v27, -v26, v24, v10
    v_fma_f32 v10, v27, v25, v26
    v_cvt_pk_bf16_f32 v10, v10, v10
    v_lshlrev_b32 v10, 16, v10
    v_lshlrev_b32 v6, 2, v0
    ds_write_b32 v6, v10
    s_waitcnt lgkmcnt(0)
    s_barrier
    v_lshlrev_b32 v8, 4, v4
    ds_read_b128 v[16:19], v8
    v_mov_b32 v64, 0
    v_mov_b32 v65, 0
    v_mov_b32 v66, 0
    v_mov_b32 v67, 0
    v_mov_b32 v68, 0
    v_mov_b32 v69, 0
    v_mov_b32 v70, 0
    v_mov_b32 v71, 0
    s_waitcnt lgkmcnt(0)
    v_lshlrev_b32 v28, 16, v32
    v_and_b32 v29, 0xffff0000, v32
    v_fmac_f32 v64, v16, v28
    v_fmac_f32 v65, v16, v29
    v_lshlrev_b32 v28, 16, v33
    v_and_b32 v29, 0xffff0000, v33
    v_fmac_f32 v66, v16, v28
    v_fmac_f32 v67, v16, v29
    v_lshlrev_b32 v28, 16, v34
    v_and_b32 v29, 0xffff0000, v34
    v_fmac_f32 v68, v16, v28
    v_fmac_f32 v69, v16, v29
    v_lshlrev_b32 v28, 16, v35
    v_and_b32 v29, 0xffff0000, v35
    v_fmac_f32 v70, v16, v28
    v_fmac_f32 v71, v16, v29
    v_lshlrev_b32 v28, 16, v36
    v_and_b32 v29, 0xffff0000, v36
    v_fmac_f32 v64, v17, v28
    v_fmac_f32 v65, v17, v29
    v_lshlrev_b32 v28, 16, v37
    v_and_b32 v29, 0xffff0000, v37
    v_fmac_f32 v66, v17, v28
    v_fmac_f32 v67, v17, v29
    v_lshlrev_b32 v28, 16, v38
    v_and_b32 v29, 0xffff0000, v38
    v_fmac_f32 v68, v17, v28
    v_fmac_f32 v69, v17, v29
    v_lshlrev_b32 v28, 16, v39
    v_and_b32 v29, 0xffff0000, v39
    v_fmac_f32 v70, v17, v28
    v_fmac_f32 v71, v17, v29
    v_lshlrev_b32 v28, 16, v40
    v_and_b32 v29, 0xffff0000, v40
    v_fmac_f32 v64, v18, v28
    v_fmac_f32 v65, v18, v29
    v_lshlrev_b32 v28, 16, v41
    v_and_b32 v29, 0xffff0000, v41
    v_fmac_f32 v66, v18, v28
    v_fmac_f32 v67, v18, v29
    v_lshlrev_b32 v28, 16, v42
    v_and_b32 v29, 0xffff0000, v42
    v_fmac_f32 v68, v18, v28
    v_fmac_f32 v69, v18, v29
    v_lshlrev_b32 v28, 16, v43
    v_and_b32 v29, 0xffff0000, v43
    v_fmac_f32 v70, v18, v28
    v_fmac_f32 v71, v18, v29
    v_lshlrev_b32 v28, 16, v44
    v_and_b32 v29, 0xffff0000, v44
    v_fmac_f32 v64, v19, v28
    v_fmac_f32 v65, v19, v29
    v_lshlrev_b32 v28, 16, v45
    v_and_b32 v29, 0xffff0000, v45
    v_fmac_f32 v66, v19, v28
    v_fmac_f32 v67, v19, v29
    v_lshlrev_b32 v28, 16, v46
    v_and_b32 v29, 0xffff0000, v46
    v_fmac_f32 v68, v19, v28
    v_fmac_f32 v69, v19, v29
    v_lshlrev_b32 v28, 16, v47
    v_and_b32 v29, 0xffff0000, v47
    v_fmac_f32 v70, v19, v28
    v_fmac_f32 v71, v19, v29
    s_nop 1
    v_add_f32_dpp v64, v64, v64 row_ror:4 row_mask:0xf bank_mask:0xf
    s_nop 1
    v_add_f32_dpp v64, v64, v64 row_ror:8 row_mask:0xf bank_mask:0xf
    v_mov_b32 v28, v64
    s_nop 1
    v_permlane16_swap_b32 v64, v28
    s_nop 1
    v_add_f32 v64, v64, v28
    v_mov_b32 v28, v64
    s_nop 1
    v_permlane32_swap_b32 v64, v28
    s_nop 1
    v_add_f32 v64, v64, v28
    s_nop 1
    v_add_f32_dpp v65, v65, v65 row_ror:4 row_mask:0xf bank_mask:0xf
    s_nop 1
    v_add_f32_dpp v65, v65, v65 row_ror:8 row_mask:0xf bank_mask:0xf
    v_mov_b32 v28, v65
    s_nop 1
    v_permlane16_swap_b32 v65, v28
    s_nop 1
    v_add_f32 v65, v65, v28
    v_mov_b32 v28, v65
    s_nop 1
    v_permlane32_swap_b32 v65, v28
    s_nop 1
    v_add_f32 v65, v65, v28
    s_nop 1
    v_add_f32_dpp v66, v66, v66 row_ror:4 row_mask:0xf bank_mask:0xf
    s_nop 1
    v_add_f32_dpp v66, v66, v66 row_ror:8 row_mask:0xf bank_mask:0xf
    v_mov_b32 v28, v66
    s_nop 1
    v_permlane16_swap_b32 v66, v28
    s_nop 1
    v_add_f32 v66, v66, v28
    v_mov_b32 v28, v66
    s_nop 1
    v_permlane32_swap_b32 v66, v28
    s_nop 1
    v_add_f32 v66, v66, v28
    s_nop 1
    v_add_f32_dpp v67, v67, v67 row_ror:4 row_mask:0xf bank_mask:0xf
    s_nop 1
    v_add_f32_dpp v67, v67, v67 row_ror:8 row_mask:0xf bank_mask:0xf
    v_mov_b32 v28, v67
    s_nop 1
    v_permlane16_swap_b32 v67, v28
    s_nop 1
    v_add_f32 v67, v67, v28
    v_mov_b32 v28, v67
    s_nop 1
    v_permlane32_swap_b32 v67, v28
    s_nop 1
    v_add_f32 v67, v67, v28
    s_nop 1
    v_add_f32_dpp v68, v68, v68 row_ror:4 row_mask:0xf bank_mask:0xf
    s_nop 1
    v_add_f32_dpp v68, v68, v68 row_ror:8 row_mask:0xf bank_mask:0xf
    v_mov_b32 v28, v68
    s_nop 1
    v_permlane16_swap_b32 v68, v28
    s_nop 1
    v_add_f32 v68, v68, v28
    v_mov_b32 v28, v68
    s_nop 1
    v_permlane32_swap_b32 v68, v28
    s_nop 1
    v_add_f32 v68, v68, v28
    s_nop 1
    v_add_f32_dpp v69, v69, v69 row_ror:4 row_mask:0xf bank_mask:0xf
    s_nop 1
    v_add_f32_dpp v69, v69, v69 row_ror:8 row_mask:0xf bank_mask:0xf
    v_mov_b32 v28, v69
    s_nop 1
    v_permlane16_swap_b32 v69, v28
    s_nop 1
    v_add_f32 v69, v69, v28
    v_mov_b32 v28, v69
    s_nop 1
    v_permlane32_swap_b32 v69, v28
    s_nop 1
    v_add_f32 v69, v69, v28
    s_nop 1
    v_add_f32_dpp v70, v70, v70 row_ror:4 row_mask:0xf bank_mask:0xf
    s_nop 1
    v_add_f32_dpp v70, v70, v70 row_ror:8 row_mask:0xf bank_mask:0xf
    v_mov_b32 v28, v70
    s_nop 1
    v_permlane16_swap_b32 v70, v28
    s_nop 1
    v_add_f32 v70, v70, v28
    v_mov_b32 v28, v70
    s_nop 1
    v_permlane32_swap_b32 v70, v28
    s_nop 1
    v_add_f32 v70, v70, v28
    s_nop 1
    v_add_f32_dpp v71, v71, v71 row_ror:4 row_mask:0xf bank_mask:0xf
    s_nop 1
    v_add_f32_dpp v71, v71, v71 row_ror:8 row_mask:0xf bank_mask:0xf
    v_mov_b32 v28, v71
    s_nop 1
    v_permlane16_swap_b32 v71, v28
    s_nop 1
    v_add_f32 v71, v71, v28
    v_mov_b32 v28, v71
    s_nop 1
    v_permlane32_swap_b32 v71, v28
    s_nop 1
    v_add_f32 v71, v71, v28
    v_lshlrev_b32 v8, 7, v3
    v_lshl_add_u32 v8, v5, 5, v8
    v_and_b32 v10, 63, v0
    v_cmp_gt_u32 vcc, 4, v10
    s_and_saveexec_b64 s[52:53], vcc
    ds_write_b128 v8, v[64:67] offset:4224
    ds_write_b128 v8, v[68:71] offset:4240
    s_mov_b64 exec, s[52:53]
    s_waitcnt lgkmcnt(0)
    s_barrier
    v_and_b32 v7, 31, v0
    v_lshlrev_b32 v8, 2, v7
    ds_read_b32 v16, v8 offset:4224
    ds_read_b32 v17, v8 offset:4352
    ds_read_b32 v18, v8 offset:4480
    ds_read_b32 v19, v8 offset:4608
    ds_read_b32 v20, v8 offset:4736
    ds_read_b32 v21, v8 offset:4864
    ds_read_b32 v22, v8 offset:4992
    ds_read_b32 v23, v8 offset:5120
    s_waitcnt lgkmcnt(0)
    v_add_f32 v16, v16, v17
    v_add_f32 v18, v18, v19
    v_add_f32 v20, v20, v21
    v_add_f32 v22, v22, v23
    v_add_f32 v16, v16, v18
    v_add_f32 v20, v20, v22
    v_add_f32 v16, v16, v20
    v_cvt_pk_bf16_f32 v16, v16, v16
    v_lshlrev_b32 v16, 16, v16
    v_lshlrev_b32 v15, 16, v15
    v_add_f32 v16, v16, v15
    v_cvt_pk_bf16_f32 v16, v16, v16
    v_lshlrev_b32 v16, 16, v16
    v_max_f32 v16, 0, v16
    v_mul_f32 v16, v16, v16
    v_cvt_pk_bf16_f32 v16, v16, v16
    v_lshlrev_b32 v16, 16, v16
    s_nop 1
    s_add_u32 s12, s3, 0
    s_nop 3
    v_readlane_b32 s44, v16, s12
    s_add_u32 s12, s3, 8
    s_nop 3
    v_readlane_b32 s45, v16, s12
    s_add_u32 s12, s3, 16
    s_nop 3
    v_readlane_b32 s46, v16, s12
    s_add_u32 s12, s3, 24
    s_nop 3
    v_readlane_b32 s47, v16, s12
    v_mov_b32 v64, 0
    v_mov_b32 v65, 0
    v_mov_b32 v66, 0
    v_mov_b32 v67, 0
    v_mov_b32 v68, 0
    v_mov_b32 v69, 0
    v_mov_b32 v70, 0
    v_mov_b32 v71, 0
    s_nop 1
    v_lshlrev_b32 v28, 16, v48
    v_and_b32 v29, 0xffff0000, v48
    v_fmac_f32 v64, s44, v28
    v_fmac_f32 v65, s44, v29
    v_lshlrev_b32 v28, 16, v49
    v_and_b32 v29, 0xffff0000, v49
    v_fmac_f32 v66, s44, v28
    v_fmac_f32 v67, s44, v29
    v_lshlrev_b32 v28, 16, v50
    v_and_b32 v29, 0xffff0000, v50
    v_fmac_f32 v68, s44, v28
    v_fmac_f32 v69, s44, v29
    v_lshlrev_b32 v28, 16, v51
    v_and_b32 v29, 0xffff0000, v51
    v_fmac_f32 v70, s44, v28
    v_fmac_f32 v71, s44, v29
    v_lshlrev_b32 v28, 16, v52
    v_and_b32 v29, 0xffff0000, v52
    v_fmac_f32 v64, s45, v28
    v_fmac_f32 v65, s45, v29
    v_lshlrev_b32 v28, 16, v53
    v_and_b32 v29, 0xffff0000, v53
    v_fmac_f32 v66, s45, v28
    v_fmac_f32 v67, s45, v29
    v_lshlrev_b32 v28, 16, v54
    v_and_b32 v29, 0xffff0000, v54
    v_fmac_f32 v68, s45, v28
    v_fmac_f32 v69, s45, v29
    v_lshlrev_b32 v28, 16, v55
    v_and_b32 v29, 0xffff0000, v55
    v_fmac_f32 v70, s45, v28
    v_fmac_f32 v71, s45, v29
    v_lshlrev_b32 v28, 16, v56
    v_and_b32 v29, 0xffff0000, v56
    v_fmac_f32 v64, s46, v28
    v_fmac_f32 v65, s46, v29
    v_lshlrev_b32 v28, 16, v57
    v_and_b32 v29, 0xffff0000, v57
    v_fmac_f32 v66, s46, v28
    v_fmac_f32 v67, s46, v29
    v_lshlrev_b32 v28, 16, v58
    v_and_b32 v29, 0xffff0000, v58
    v_fmac_f32 v68, s46, v28
    v_fmac_f32 v69, s46, v29
    v_lshlrev_b32 v28, 16, v59
    v_and_b32 v29, 0xffff0000, v59
    v_fmac_f32 v70, s46, v28
    v_fmac_f32 v71, s46, v29
    v_lshlrev_b32 v28, 16, v60
    v_and_b32 v29, 0xffff0000, v60
    v_fmac_f32 v64, s47, v28
    v_fmac_f32 v65, s47, v29
    v_lshlrev_b32 v28, 16, v61
    v_and_b32 v29, 0xffff0000, v61
    v_fmac_f32 v66, s47, v28
    v_fmac_f32 v67, s47, v29
    v_lshlrev_b32 v28, 16, v62
    v_and_b32 v29, 0xffff0000, v62
    v_fmac_f32 v68, s47, v28
    v_fmac_f32 v69, s47, v29
    v_lshlrev_b32 v28, 16, v63
    v_and_b32 v29, 0xffff0000, v63
    v_fmac_f32 v70, s47, v28
    v_fmac_f32 v71, s47, v29
    v_and_b32 v7, 63, v0
    v_lshlrev_b32 v8, 11, v3
    v_lshl_add_u32 v8, v7, 5, v8
    ds_write_b128 v8, v[64:67] offset:8192
    ds_write_b128 v8, v[68:71] offset:8208
    s_waitcnt lgkmcnt(0)
    s_barrier
    ds_read_b32 v16, v6 offset:8192
    ds_read_b32 v17, v6 offset:10240
    ds_read_b32 v18, v6 offset:12288
    ds_read_b32 v19, v6 offset:14336
    ds_read_b32 v20, v6 offset:16384
    ds_read_b32 v21, v6 offset:18432
    ds_read_b32 v22, v6 offset:20480
    ds_read_b32 v23, v6 offset:22528
    s_waitcnt lgkmcnt(0)
    v_add_f32 v16, v16, v17
    v_add_f32 v18, v18, v19
    v_add_f32 v20, v20, v21
    v_add_f32 v22, v22, v23
    v_add_f32 v16, v16, v18
    v_add_f32 v20, v20, v22
    v_add_f32 v16, v16, v20
    v_mov_b32 v17, 1
    v_lshlrev_b32 v8, 3, v0
    s_lshl_b32 s12, s14, 12
    s_add_u32 s12, s12, 630784
    buffer_store_dwordx2 v[16:17], v8, s[24:27], s12 offen sc1
    s_branch k3_end
r_fin:
    s_sub_u32 s14, s2, 120
    s_mov_b32 s36, s82
    s_and_b32 s37, s83, 0xffff
    s_mov_b32 s38, 1024
    s_mov_b32 s39, 0x00020000
    s_mov_b32 s92, s64
    s_and_b32 s93, s65, 0xffff
    s_mov_b32 s94, 1024
    s_mov_b32 s95, 0x00020000
    v_and_b32 v7, 63, v0
    s_lshl_b32 s12, s14, 6
    v_add_u32 v7, s12, v7
    v_lshlrev_b32 v10, 1, v7
    buffer_load_ushort v12, v10, s[36:39], 0 offen
    buffer_load_ushort v13, v10, s[92:95], 0 offen
    v_lshlrev_b32 v8, 3, v7
    v_lshl_add_u32 v11, v3, 12, v8
    s_mov_b32 s56, 598016
    s_mov_b32 s57, 630784
    s_mov_b32 s58, 663552
    s_mov_b32 s59, 696320
    s_mov_b32 s60, 729088
    s_mov_b32 s61, 761856
    s_mov_b32 s62, 794624
    s_mov_b32 s63, 827392
    s_mov_b32 s50, 0
pz_loop:
    buffer_load_dwordx2 v[64:65], v11, s[24:27], s56 offen sc1
    buffer_load_dwordx2 v[66:67], v11, s[24:27], s57 offen sc1
    buffer_load_dwordx2 v[68:69], v11, s[24:27], s58 offen sc1
    buffer_load_dwordx2 v[70:71], v11, s[24:27], s59 offen sc1
    buffer_load_dwordx2 v[72:73], v11, s[24:27], s60 offen sc1
    buffer_load_dwordx2 v[74:75], v11, s[24:27], s61 offen sc1
    buffer_load_dwordx2 v[76:77], v11, s[24:27], s62 offen sc1
    buffer_load_dwordx2 v[78:79], v11, s[24:27], s63 offen sc1
    s_waitcnt vmcnt(0)
    v_and_b32 v9, v65, v67
    v_and_b32 v9, v9, v69
    v_and_b32 v9, v9, v71
    v_and_b32 v9, v9, v73
    v_and_b32 v9, v9, v75
    v_and_b32 v9, v9, v77
    v_and_b32 v9, v9, v79
    v_cmp_eq_u32 vcc, 1, v9
    s_add_u32 s50, s50, 1
    s_nop 1
    s_cmp_eq_u64 vcc, exec
    s_cbranch_scc1 pz_done
    s_cmp_lt_u32 s50, 400000
    s_cbranch_scc1 pz_loop
pz_done:
    v_add_f32 v66, v66, v68
    v_add_f32 v66, v66, v70
    v_add_f32 v66, v66, v72
    v_add_f32 v66, v66, v74
    v_add_f32 v66, v66, v76
    v_add_f32 v66, v66, v78
    v_lshlrev_b32 v6, 3, v0
    v_mov_b32 v65, v66
    ds_write_b64 v6, v[64:65]
    s_waitcnt lgkmcnt(0)
    s_barrier
    s_cmp_lg_u32 s3, 0
    s_cbranch_scc1 k3_end
    ds_read_b64 v[16:17], v6 offset:0
    ds_read_b64 v[18:19], v6 offset:512
    ds_read_b64 v[20:21], v6 offset:1024
    ds_read_b64 v[22:23], v6 offset:1536
    ds_read_b64 v[24:25], v6 offset:2048
    ds_read_b64 v[26:27], v6 offset:2560
    ds_read_b64 v[28:29], v6 offset:3072
    ds_read_b64 v[30:31], v6 offset:3584
    s_waitcnt lgkmcnt(0)
    v_add_f32 v16, v16, v18
    v_add_f32 v20, v20, v22
    v_add_f32 v24, v24, v26
    v_add_f32 v28, v28, v30
    v_add_f32 v16, v16, v20
    v_add_f32 v24, v24, v28
    v_add_f32 v16, v16, v24
    v_add_f32 v17, v17, v19
    v_add_f32 v21, v21, v23
    v_add_f32 v25, v25, v27
    v_add_f32 v29, v29, v31
    v_add_f32 v17, v17, v21
    v_add_f32 v25, v25, v29
    v_add_f32 v17, v17, v25
    v_cvt_pk_bf16_f32 v16, v16, v16
    v_lshlrev_b32 v16, 16, v16
    v_lshlrev_b32 v13, 16, v13
    v_add_f32 v16, v16, v13
    v_cvt_pk_bf16_f32 v16, v16, v16
    v_lshlrev_b32 v16, 16, v16
    v_cvt_pk_bf16_f32 v17, v17, v17
    v_lshlrev_b32 v17, 16, v17
    v_lshlrev_b32 v12, 16, v12
    v_add_f32 v17, v17, v12
    v_cvt_pk_bf16_f32 v17, v17, v17
    v_lshlrev_b32 v17, 16, v17
    v_add_f32 v17, v17, v16
    v_cvt_pk_bf16_f32 v17, v17, v17
    s_mov_b32 s36, s84
    s_and_b32 s37, s85, 0xffff
    s_mov_b32 s38, 1024
    s_mov_b32 s39, 0x00020000
    buffer_store_short v17, v10, s[36:39], 0 offen
k3_end:
    s_endpgm
.section .rodata,"a"
.p2align 6
.amdhsa_kernel k3_tail_kernel
  .amdhsa_next_free_vgpr 128
  .amdhsa_next_free_sgpr 102
  .amdhsa_accum_offset 128
  .amdhsa_group_segment_fixed_size 0
  .amdhsa_kernarg_size 104
  .amdhsa_user_sgpr_count 2
  .amdhsa_user_sgpr_kernarg_segment_ptr 1
  .amdhsa_system_sgpr_workgroup_id_x 1
.end_amdhsa_kernel
.text
```
